```python
import torch

def _softmax(x, axis=-1):
    return torch.softmax(x, dim=axis)
def _gelu(x):
    return torch.nn.functional.gelu(x, approximate="tanh")
def _silu(x):
    return torch.nn.functional.silu(x)
def _sigmoid(x):
    return torch.sigmoid(x)
def _layernorm(x, axis=-1, eps=1e-5):
    m = x.mean(dim=axis, keepdim=True)
    v = x.var(dim=axis, keepdim=True, unbiased=False)
    return (x - m) / torch.sqrt(v + eps)
def _scatter_add(tgt, idx, src, axis=0):
    return tgt.clone().index_add_(axis, idx, src)
def _segment_sum(src, seg, n):
    out = torch.zeros((n,) + src.shape[1:], dtype=src.dtype)
    return out.index_add_(0, seg, src)
def _pad(x, pw):
    flat = tuple(v for pair in reversed(pw) for v in pair)
    return torch.nn.functional.pad(x, flat)

kernel_name = 'gather_scatter__cheap_equivariant_egnn__graph'

def setup_inputs():

    _w = (lambda a: (lambda t: t.to(torch.bfloat16) if t.is_floating_point() else t)(torch.as_tensor(a)))
    N, deg, D, De = 25000, 32, 64, max(4, 1)
    E = N * deg
    return {
        "h": _w((lambda *s: torch.randn(*s, dtype=torch.bfloat16) * 0.2)(N, D)),
        "pos": _w((lambda *s: torch.randn(*s, dtype=torch.bfloat16) * 0.8)(N, 3)),
        "e_attr": _w((lambda *s: torch.randn(*s, dtype=torch.bfloat16) * 0.8)(E, De)),
        "src": _w((lambda lo, hi, *s: torch.randint(lo, hi, s))(0, N, E).to(torch.int64)),
        "dst": _w((lambda lo, hi, *s: torch.randint(lo, hi, s))(0, N, E).to(torch.int64)),
        "w_e": _w(0.1 * (lambda *s: torch.randn(*s, dtype=torch.bfloat16) * 0.8)(2 * D + 1 + De, D)),
        "w_x": _w(0.1 * (lambda *s: torch.randn(*s, dtype=torch.bfloat16) * 0.2)(D, 1)),
        "w_h": _w(0.1 * (lambda *s: torch.randn(*s, dtype=torch.bfloat16) * 0.2)(2 * D, D)),
    }

def reference(h, pos, e_attr, src, dst, w_e, w_x, w_h):
    N, D = h.shape[0], h.shape[1]
    diff = pos[dst] - pos[src]
    dist2 = torch.sum(diff * diff, axis=-1, keepdims=True)
    e_in = torch.concatenate([h[dst], h[src], dist2, e_attr], axis=-1)
    m_ij = _silu(e_in @ w_e)
    coord_scale = m_ij @ w_x
    pos_new = pos + _segment_sum(diff * coord_scale, dst, N)
    m_i = _segment_sum(m_ij, dst, N)
    h_new = h + _silu(torch.concatenate([h, m_i], axis=-1) @ w_h)
    return h_new, pos_new
```

```asm
; @launch grid=(256,1,1) block=(512,1,1) lds=159488
.amdgcn_target "amdgcn-amd-amdhsa--gfx950"
.text
.globl gather_scatter__cheap_equivariant_egnn__graph_kernel
.p2align 8
.type gather_scatter__cheap_equivariant_egnn__graph_kernel,@function
gather_scatter__cheap_equivariant_egnn__graph_kernel:
    s_cmp_ge_u32 s2, 256
    s_cbranch_scc1 K_END
    s_load_dwordx16 s[32:47], s[0:1], 0
    s_load_dwordx4 s[48:51], s[0:1], 64
    s_load_dwordx2 s[52:53], s[0:1], 80
    s_cmp_eq_u32 s2, 255
    s_movk_i32 s4, 270
    s_cselect_b32 s4, 78, s4
    s_mul_i32 s3, s2, 12512
    s_lshl_b32 s5, s3, 1
    v_lshlrev_b32 v8, 4, v0
    v_lshlrev_b32 v9, 5, v0
    v_cmp_gt_u32 s[62:63], s4, v0
    v_mov_b32 v12, 0x40000000
    v_add_u32 v10, 0x2000, v8
    v_add_u32 v11, 0x4000, v9
    v_cndmask_b32 v10, v12, v10, s[62:63]
    v_cndmask_b32 v11, v12, v11, s[62:63]
    v_and_b32 v12, 0xff, v0
    v_lshlrev_b32 v12, 2, v12
    v_mov_b32 v250, 0
    ds_write_b32 v12, v250 offset:58368
    s_waitcnt lgkmcnt(0)
    s_mov_b32 s8, s40
    s_mov_b32 s9, s41
    s_mov_b32 s10, 0x30d400
    s_mov_b32 s11, 0x20000
    s_mov_b32 s12, s38
    s_mov_b32 s13, s39
    s_mov_b32 s14, 0x30d400
    s_mov_b32 s15, 0x20000
    s_mov_b32 s16, s36
    s_mov_b32 s17, s37
    s_mov_b32 s18, 0x61a800
    s_mov_b32 s19, 0x20000
    buffer_load_dwordx4 v[16:19], v8, s[8:11], s3 offen nt
    buffer_load_dwordx4 v[20:23], v10, s[8:11], s3 offen nt
    buffer_load_dwordx4 v[24:27], v8, s[12:15], s3 offen nt
    buffer_load_dwordx4 v[28:31], v10, s[12:15], s3 offen nt
    buffer_load_dwordx4 v[32:35], v9, s[16:19], s5 offen nt
    buffer_load_dwordx4 v[36:39], v9, s[16:19], s5 offen offset:16 nt
    buffer_load_dwordx4 v[40:43], v11, s[16:19], s5 offen nt
    buffer_load_dwordx4 v[44:47], v11, s[16:19], s5 offen offset:16 nt
    s_barrier
    v_and_b32 v1, 63, v0
    v_lshrrev_b32 v12, 6, v0
    s_nop 0
    v_readfirstlane_b32 s64, v12
    s_mov_b32 s28, s50
    s_mov_b32 s29, s51
    s_mov_b32 s30, 0x100
    s_mov_b32 s31, 0x20000
    v_mov_b32 v12, 0
    s_cmp_lg_u32 s2, 0
    s_cbranch_scc1 K_NOEP
    s_cmp_lg_u32 s64, 7
    s_cbranch_scc1 K_NOEP
    s_memrealtime s[4:5]
    s_waitcnt lgkmcnt(0)
    s_or_b32 s4, s4, 1
    v_mov_b32 v13, s4
    s_mov_b64 exec, 1
    buffer_store_dword v13, v12, s[28:31], 0 offen sc0 sc1
    s_mov_b64 exec, -1
K_NOEP:
    v_mov_b32 v251, 0
    s_and_b32 s3, s2, 7
    s_lshl_b32 s3, s3, 5
    s_lshr_b32 s65, s2, 3
    s_add_u32 s65, s65, s3
    s_lshl_b32 s4, s65, 20
    s_add_u32 s4, s4, 10736
    s_mov_b32 s7, 51201995
    v_lshl_add_u32 v12, v1, 16, s4
    v_add_u32 v13, 0x10000, v12
    v_mul_hi_u32 v12, v12, s7
    v_mul_hi_u32 v13, v13, s7
    v_lshrrev_b32 v12, 7, v12
    v_lshrrev_b32 v13, 7, v13
    v_min_u32 v13, 25000, v13
    s_mov_b32 s4, s64
    s_add_u32 s5, s4, 8
    v_readlane_b32 s3, v12, 0
    v_readlane_b32 s68, v13, s4
    v_readlane_b32 s66, v12, s4
    v_readlane_b32 s67, v12, s5
    v_readlane_b32 s69, v13, s5
    v_mul_u32_u24 v14, 384, v1
    s_lshl_b32 s3, s3, 7
    s_sub_u32 s3, 102656, s3
    v_lshl_add_u32 v235, v12, 7, v14
    v_add_u32 v235, s3, v235
    v_lshl_add_u32 v239, v13, 7, v14
    s_add_u32 s3, s3, 384
    v_add_u32 v239, s3, v239
    v_cmp_gt_u32 vcc, 16, v1
    s_sub_u32 s69, s69, s67
    s_sub_u32 s68, s68, s66
    v_cndmask_b32 v235, 0, v235, vcc
    v_and_b32 v9, 31, v1
    v_lshrrev_b32 v10, 5, v1
    v_lshlrev_b32 v11, 4, v1
    v_and_b32 v12, 7, v1
    v_cmp_gt_u32 vcc, 8, v1
    v_mov_b32 v13, s67
    v_mov_b32 v14, s66
    v_cndmask_b32 v13, v13, v14, vcc
    v_mov_b32 v14, s69
    v_mov_b32 v15, s68
    v_cndmask_b32 v14, v14, v15, vcc
    v_cmp_lt_u32 vcc, v12, v14
    v_cmp_gt_u32 s[60:61], 16, v1
    v_add_u32 v13, v13, v12
    v_mov_b32 v14, 0x7fff
    s_and_b64 vcc, vcc, s[60:61]
    v_cndmask_b32 v253, v14, v13, vcc
    v_mul_u32_u24 v252, 6, v253
    s_mov_b32 s20, s34
    s_mov_b32 s21, s35
    s_mov_b32 s22, 0x249f0
    s_mov_b32 s23, 0x20000
    v_and_b32 v12, 3, v9
    v_bfe_u32 v13, v9, 3, 1
    v_lshl_or_b32 v12, v13, 2, v12
    v_cmp_gt_u32 vcc, 16, v9
    v_mov_b32 v13, s67
    v_mov_b32 v14, s66
    v_cndmask_b32 v13, v13, v14, vcc
    v_mov_b32 v14, s69
    v_mov_b32 v15, s68
    v_cndmask_b32 v14, v14, v15, vcc
    v_and_b32 v15, 4, v9
    v_lshl_or_b32 v15, v15, 1, v12
    v_cmp_lt_u32 vcc, v15, v14
    v_add_u32 v13, v13, v12
    v_lshlrev_b32 v13, 7, v13
    v_lshl_add_u32 v13, v10, 4, v13
    v_mov_b32 v14, 0x40000000
    v_cndmask_b32 v247, v14, v13, vcc
    s_mov_b32 s8, s32
    s_mov_b32 s9, s33
    s_mov_b32 s10, 0x30d400
    s_mov_b32 s11, 0x20000
    s_mov_b32 s56, s42
    s_mov_b32 s57, s43
    s_mov_b32 s58, 0x4280
    s_mov_b32 s59, 0x20000
    s_mov_b32 s40, s46
    s_mov_b32 s41, s47
    s_mov_b32 s42, 0x4000
    s_mov_b32 s43, 0x20000
    s_add_u32 s12, s52, 0xb00000
    s_addc_u32 s13, s53, 0
    s_or_b32 s13, s13, 0x100000
    s_mov_b32 s14, 0x61a8
    s_mov_b32 s15, 0x20000
    s_mov_b32 s16, s52
    s_mov_b32 s17, s53
    s_mov_b32 s18, 0xb00000
    s_mov_b32 s19, 0x20000
    v_mov_b32 v14, 12
    s_mul_i32 s54, s2, 37632
    s_waitcnt vmcnt(7)
    v_mul_u32_u24 v48, 0x29f1, v16
    v_lshrrev_b32 v56, 18, v48
    v_and_b32 v56, 0x3fc, v56
    ds_add_rtn_u32 v64, v56, v14 offset:58368
    v_mul_u32_u24 v49, 0x29f1, v17
    v_lshrrev_b32 v57, 18, v49
    v_and_b32 v57, 0x3fc, v57
    ds_add_rtn_u32 v65, v57, v14 offset:58368
    v_mul_u32_u24 v50, 0x29f1, v18
    v_lshrrev_b32 v58, 18, v50
    v_and_b32 v58, 0x3fc, v58
    ds_add_rtn_u32 v66, v58, v14 offset:58368
    v_mul_u32_u24 v51, 0x29f1, v19
    v_lshrrev_b32 v59, 18, v51
    v_and_b32 v59, 0x3fc, v59
    ds_add_rtn_u32 v67, v59, v14 offset:58368
    s_waitcnt vmcnt(6)
    s_mov_b64 exec, s[62:63]
    v_mul_u32_u24 v52, 0x29f1, v20
    v_lshrrev_b32 v60, 18, v52
    v_and_b32 v60, 0x3fc, v60
    ds_add_rtn_u32 v68, v60, v14 offset:58368
    v_mul_u32_u24 v53, 0x29f1, v21
    v_lshrrev_b32 v61, 18, v53
    v_and_b32 v61, 0x3fc, v61
    ds_add_rtn_u32 v69, v61, v14 offset:58368
    v_mul_u32_u24 v54, 0x29f1, v22
    v_lshrrev_b32 v62, 18, v54
    v_and_b32 v62, 0x3fc, v62
    ds_add_rtn_u32 v70, v62, v14 offset:58368
    v_mul_u32_u24 v55, 0x29f1, v23
    v_lshrrev_b32 v63, 18, v55
    v_and_b32 v63, 0x3fc, v63
    ds_add_rtn_u32 v71, v63, v14 offset:58368
    s_mov_b64 exec, -1
    buffer_load_ushort v156, v252, s[20:23], 0 offen offset:0
    buffer_load_ushort v157, v252, s[20:23], 0 offen offset:2
    buffer_load_ushort v158, v252, s[20:23], 0 offen offset:4
    buffer_load_dword v160, v250, s[28:31], 0 offen sc0 sc1
    buffer_load_dwordx4 v[80:83], v247, s[8:11], 0 offen offset:0
    buffer_load_dwordx4 v[84:87], v247, s[8:11], 0 offen offset:32
    buffer_load_dwordx4 v[88:91], v247, s[8:11], 0 offen offset:64
    buffer_load_dwordx4 v[92:95], v247, s[8:11], 0 offen offset:96
    s_mov_b32 s6, 400016
    v_and_b32 v16, 0xffff, v48
    v_mul_hi_u32 v16, v16, s6
    v_bfe_u32 v48, v48, 16, 4
    v_lshlrev_b32 v16, 3, v16
    v_lshl_or_b32 v16, v48, 24, v16
    v_and_b32 v17, 0xffff, v49
    v_mul_hi_u32 v17, v17, s6
    v_bfe_u32 v49, v49, 16, 4
    v_lshlrev_b32 v17, 3, v17
    v_lshl_or_b32 v17, v49, 24, v17
    v_and_b32 v18, 0xffff, v50
    v_mul_hi_u32 v18, v18, s6
    v_bfe_u32 v50, v50, 16, 4
    v_lshlrev_b32 v18, 3, v18
    v_lshl_or_b32 v18, v50, 24, v18
    v_and_b32 v19, 0xffff, v51
    v_mul_hi_u32 v19, v19, s6
    v_bfe_u32 v51, v51, 16, 4
    v_lshlrev_b32 v19, 3, v19
    v_lshl_or_b32 v19, v51, 24, v19
    v_and_b32 v20, 0xffff, v52
    v_mul_hi_u32 v20, v20, s6
    v_bfe_u32 v52, v52, 16, 4
    v_lshlrev_b32 v20, 3, v20
    v_lshl_or_b32 v20, v52, 24, v20
    v_and_b32 v21, 0xffff, v53
    v_mul_hi_u32 v21, v21, s6
    v_bfe_u32 v53, v53, 16, 4
    v_lshlrev_b32 v21, 3, v21
    v_lshl_or_b32 v21, v53, 24, v21
    v_and_b32 v22, 0xffff, v54
    v_mul_hi_u32 v22, v22, s6
    v_bfe_u32 v54, v54, 16, 4
    v_lshlrev_b32 v22, 3, v22
    v_lshl_or_b32 v22, v54, 24, v22
    v_and_b32 v23, 0xffff, v55
    v_mul_hi_u32 v23, v23, s6
    v_bfe_u32 v55, v55, 16, 4
    v_lshlrev_b32 v23, 3, v23
    v_lshl_or_b32 v23, v55, 24, v23
    s_waitcnt lgkmcnt(0)
    s_barrier
    ds_read_b128 v[72:75], v11 offset:58368
    s_lshl_b32 s4, s64, 8
    v_lshl_add_u32 v15, v1, 2, s4
    ds_read_b32 v76, v15 offset:58368
    s_waitcnt lgkmcnt(1)
    v_add_u32 v49, v72, v73
    v_add_u32 v50, v49, v74
    v_add_u32 v51, v50, v75
    v_mov_b32 v52, v51
    s_nop 1
    v_add_u32_dpp v52, v52, v52 row_shr:1 row_mask:0xf bank_mask:0xf bound_ctrl:0
    s_nop 1
    v_add_u32_dpp v52, v52, v52 row_shr:2 row_mask:0xf bank_mask:0xf bound_ctrl:0
    s_nop 1
    v_add_u32_dpp v52, v52, v52 row_shr:4 row_mask:0xf bank_mask:0xf bound_ctrl:0
    s_nop 1
    v_add_u32_dpp v52, v52, v52 row_shr:8 row_mask:0xf bank_mask:0xf bound_ctrl:0
    s_nop 1
    v_add_u32_dpp v52, v52, v52 row_bcast:15 row_mask:0xa bank_mask:0xf
    s_nop 1
    v_add_u32_dpp v52, v52, v52 row_bcast:31 row_mask:0xc bank_mask:0xf
    v_sub_u32 v52, v52, v51
    v_add_u32 v53, v52, v72
    v_add_u32 v54, v52, v49
    v_add_u32 v55, v52, v50
    ds_write_b128 v11, v[52:55] offset:59392
    s_waitcnt lgkmcnt(0)
    ds_read_b32 v48, v56 offset:59392
    ds_read_b32 v49, v57 offset:59392
    ds_read_b32 v50, v58 offset:59392
    ds_read_b32 v51, v59 offset:59392
    ds_read_b32 v52, v60 offset:59392
    ds_read_b32 v53, v61 offset:59392
    ds_read_b32 v54, v62 offset:59392
    ds_read_b32 v55, v63 offset:59392
    ds_read_b32 v77, v15 offset:59392
    s_waitcnt vmcnt(12)
    v_lshl_or_b32 v16, v24, 7, v16
    v_lshl_or_b32 v17, v25, 7, v17
    v_lshl_or_b32 v18, v26, 7, v18
    v_lshl_or_b32 v19, v27, 7, v19
    v_lshl_or_b32 v20, v28, 7, v20
    v_lshl_or_b32 v21, v29, 7, v21
    v_lshl_or_b32 v22, v30, 7, v22
    v_lshl_or_b32 v23, v31, 7, v23
    s_waitcnt lgkmcnt(0)
    v_add_u32 v48, v48, v64
    v_add_u32 v49, v49, v65
    v_add_u32 v50, v50, v66
    v_add_u32 v51, v51, v67
    v_add_u32 v52, v52, v68
    v_add_u32 v53, v53, v69
    v_add_u32 v54, v54, v70
    v_add_u32 v55, v55, v71
    v_lshl_or_b32 v76, v76, 16, v77
    ds_write_b32 v48, v16 offset:20744
    ds_write_b32 v49, v17 offset:20744
    ds_write_b32 v50, v18 offset:20744
    ds_write_b32 v51, v19 offset:20744
    v_add_u32 v56, 20736, v48
    v_add_u32 v57, 20736, v49
    v_add_u32 v58, 20736, v50
    v_add_u32 v59, 20736, v51
    s_waitcnt vmcnt(10)
    ds_write2_b32 v56, v32, v33 offset0:0 offset1:1
    ds_write2_b32 v57, v34, v35 offset0:0 offset1:1
    ds_write2_b32 v58, v36, v37 offset0:0 offset1:1
    ds_write2_b32 v59, v38, v39 offset0:0 offset1:1
    s_mov_b64 exec, s[62:63]
    ds_write_b32 v52, v20 offset:20744
    ds_write_b32 v53, v21 offset:20744
    ds_write_b32 v54, v22 offset:20744
    ds_write_b32 v55, v23 offset:20744
    v_add_u32 v60, 20736, v52
    v_add_u32 v61, 20736, v53
    v_add_u32 v62, 20736, v54
    v_add_u32 v63, 20736, v55
    s_waitcnt vmcnt(8)
    ds_write2_b32 v60, v40, v41 offset0:0 offset1:1
    ds_write2_b32 v61, v42, v43 offset0:0 offset1:1
    ds_write2_b32 v62, v44, v45 offset0:0 offset1:1
    ds_write2_b32 v63, v46, v47 offset0:0 offset1:1
    s_mov_b64 exec, -1
    v_cmp_gt_u32 vcc, 304, v0
    v_mov_b32 v12, 0x40000000
    s_nop 0
    v_cndmask_b32 v12, v12, v8, vcc
    s_waitcnt vmcnt(5)
    v_lshlrev_b32 v68, 16, v156
    v_lshlrev_b32 v69, 16, v157
    v_lshlrev_b32 v70, 16, v158
    v_mov_b32 v71, 0
    s_mov_b64 exec, 0xffff
    buffer_store_dwordx4 v[68:71], v253, s[12:15], 0 idxen sc1
    s_mov_b64 exec, -1
    s_movk_i32 s4, 0x2000
    buffer_load_dwordx4 v[148:151], v8, s[56:59], s4 offen
    s_movk_i32 s4, 0x4000
    buffer_load_dwordx4 v[152:155], v11, s[56:59], s4 offen
    s_lshl_b32 s5, s64, 10
    s_add_u32 m0, s5, 69888
    s_nop 0
    buffer_load_dwordx4 v8, s[56:59], 0 offen lds
    s_add_u32 m0, s5, 86272
    s_nop 0
    buffer_load_dwordx4 v8, s[40:43], 0 offen lds
    s_add_u32 m0, s5, 94464
    s_movk_i32 s4, 0x2000
    buffer_load_dwordx4 v8, s[40:43], s4 offen lds
    s_waitcnt lgkmcnt(0)
    s_barrier
    s_setprio 3
    ds_read_b128 v[16:19], v8 offset:20736
    ds_read_b128 v[20:23], v8 offset:28928
    ds_read_b128 v[24:27], v8 offset:37120
    ds_read_b128 v[28:31], v8 offset:45312
    ds_read_b128 v[32:35], v8 offset:53504
    s_waitcnt lgkmcnt(4)
    buffer_store_dwordx4 v[16:19], v8, s[16:19], s54 offen sc1
    s_add_u32 s54, s54, 8192
    s_waitcnt lgkmcnt(3)
    buffer_store_dwordx4 v[20:23], v8, s[16:19], s54 offen sc1
    s_add_u32 s54, s54, 8192
    s_waitcnt lgkmcnt(2)
    buffer_store_dwordx4 v[24:27], v8, s[16:19], s54 offen sc1
    s_add_u32 s54, s54, 8192
    s_waitcnt lgkmcnt(1)
    buffer_store_dwordx4 v[28:31], v8, s[16:19], s54 offen sc1
    s_add_u32 s54, s54, 8192
    s_waitcnt lgkmcnt(0)
    buffer_store_dwordx4 v[32:35], v12, s[16:19], s54 offen sc1
    s_setprio 0
    v_lshlrev_b32 v249, 2, v1
    s_mov_b64 exec, 0x1ffff
    ds_write_b32 v249, v235
    s_mov_b64 exec, -1
    v_readlane_b32 s4, v235, s64
    v_mov_b32 v12, -1
    s_nop 0
    v_add_u32 v13, s4, v249
    ds_write_b32 v13, v12
    s_mov_b32 s70, -1
    s_mov_b32 s71, 0
    s_mov_b32 s72, 0
    s_mov_b32 s73, -1
    s_lshl_b32 s76, s64, 8
    s_add_u32 s76, s76, 256
    s_add_u32 s77, s76, 2048
    v_and_b32 v12, 7, v1
    v_lshrrev_b32 v13, 1, v12
    v_and_b32 v14, 1, v12
    v_lshlrev_b32 v14, 4, v14
    v_mov_b32 v60, 0x3f80
    v_lshlrev_b32 v14, v14, v60
    v_cmp_eq_u32 vcc, 0, v13
    s_nop 1
    v_cndmask_b32 v48, 0, v14, vcc
    v_cmp_eq_u32 vcc, 1, v13
    s_nop 1
    v_cndmask_b32 v49, 0, v14, vcc
    v_cmp_eq_u32 vcc, 2, v13
    s_nop 1
    v_cndmask_b32 v50, 0, v14, vcc
    v_cmp_eq_u32 vcc, 3, v13
    s_nop 1
    v_cndmask_b32 v51, 0, v14, vcc
    v_bfe_u32 v13, v1, 3, 1
    v_lshlrev_b32 v13, 11, v13
    v_lshl_add_u32 v13, v12, 4, v13
    v_add_u32 v7, s76, v13
    s_mov_b64 exec, 0xffff
    ds_write_b128 v7, v[48:51]
    ds_write_b128 v7, v[68:71] offset:128
    s_mov_b64 exec, -1
    s_mov_b32 s24, s48
    s_mov_b32 s25, s49
    s_mov_b32 s26, 0x331df0
    s_mov_b32 s27, 0x20000
    s_mov_b32 s96, s44
    s_mov_b32 s97, s45
    s_mov_b32 s98, 0x80
    s_mov_b32 s99, 0x20000
    s_mov_b32 s74, 0x3fff80
    s_lshl_b32 s86, s64, 13
    s_add_u32 s86, s86, 20736
    s_mov_b32 s87, 384
    s_mov_b32 s88, 1
    s_mov_b32 s82, 121344
    s_mov_b32 s83, 121472
    s_lshl_b32 s94, s2, 3
    s_add_u32 s94, s94, s64
    s_lshl_b32 s94, s94, 14
    s_mul_i32 s93, s64, 1204224
    v_mov_b32 v6, 4
    v_mul_u32_u24 v3, 12, v9
    v_mul_u32_u24 v4, 37632, v10
    v_add_u32 v4, v4, v3
    v_lshlrev_b32 v5, 2, v10
    s_lshl_b32 s4, s64, 11
    s_add_u32 s4, s4, 4352
    v_mov_b32 v48, 0
    v_mov_b32 v49, 0
    v_mov_b32 v50, 0
    v_mov_b32 v51, 0
    v_add_u32 v12, s4, v11
    ds_write_b128 v12, v[48:51]
    ds_write_b128 v12, v[48:51] offset:1024
    v_lshl_add_u32 v221, v9, 6, s4
    v_bfe_u32 v12, v1, 2, 2
    v_lshl_add_u32 v12, v10, 2, v12
    v_lshlrev_b32 v12, 6, v12
    v_bfe_u32 v13, v1, 4, 1
    v_lshl_add_u32 v12, v13, 5, v12
    v_and_b32 v13, 3, v1
    v_lshl_add_u32 v12, v13, 3, v12
    v_add_u32 v220, s4, v12
    v_and_b32 v12, 7, v1
    v_bfe_u32 v13, v1, 4, 1
    v_lshlrev_b32 v13, 2, v13
    v_xor_b32 v12, v12, v13
    v_xor_b32 v13, 0, v12
    v_lshlrev_b32 v212, 4, v13
    v_xor_b32 v13, 1, v12
    v_lshlrev_b32 v213, 4, v13
    v_xor_b32 v13, 2, v12
    v_lshlrev_b32 v214, 4, v13
    v_xor_b32 v13, 3, v12
    v_lshlrev_b32 v215, 4, v13
    v_and_b32 v12, 3, v9
    v_lshrrev_b32 v13, 2, v9
    v_lshl_add_u32 v13, v12, 3, v13
    v_lshlrev_b32 v13, 7, v13
    v_add_u32 v13, s86, v13
    v_bfe_u32 v14, v9, 3, 1
    v_lshl_or_b32 v12, v14, 2, v12
    v_xor_b32 v12, v12, v10
    v_xor_b32 v14, 0, v12
    v_lshl_add_u32 v216, v14, 4, v13
    v_xor_b32 v14, 2, v12
    v_lshl_add_u32 v217, v14, 4, v13
    v_xor_b32 v14, 4, v12
    v_lshl_add_u32 v218, v14, 4, v13
    v_xor_b32 v14, 6, v12
    v_lshl_add_u32 v219, v14, 4, v13
    v_lshrrev_b32 v12, 3, v1
    v_lshlrev_b32 v222, 4, v12
    v_lshlrev_b32 v223, 2, v9
    v_mov_b32 v12, 0x3fffb8
    v_add_u32 v13, s82, v223
    ds_write_b32 v13, v12
    ds_write2st64_b32 v13, v250, v250 offset0:74 offset1:148
    v_mov_b32 v99, 0
    s_mov_b32 s4, 0xbfb8aa3b
    s_mov_b32 s5, s4
    s_waitcnt vmcnt(8)
    v_lshlrev_b32 v32, 16, v148
    v_and_b32 v33, 0xffff0000, v148
    v_lshlrev_b32 v34, 16, v149
    v_and_b32 v35, 0xffff0000, v149
    v_lshlrev_b32 v36, 16, v150
    v_and_b32 v37, 0xffff0000, v150
    v_lshlrev_b32 v38, 16, v151
    v_and_b32 v39, 0xffff0000, v151
    v_lshlrev_b32 v40, 16, v152
    v_and_b32 v41, 0xffff0000, v152
    v_lshlrev_b32 v42, 16, v153
    v_and_b32 v43, 0xffff0000, v153
    v_lshlrev_b32 v44, 16, v154
    v_and_b32 v45, 0xffff0000, v154
    v_lshlrev_b32 v46, 16, v155
    v_and_b32 v47, 0xffff0000, v155
    v_pk_mul_f32 v[32:33], v[32:33], s[4:5]
    v_pk_mul_f32 v[34:35], v[34:35], s[4:5]
    v_pk_mul_f32 v[36:37], v[36:37], s[4:5]
    v_pk_mul_f32 v[38:39], v[38:39], s[4:5]
    v_pk_mul_f32 v[40:41], v[40:41], s[4:5]
    v_pk_mul_f32 v[42:43], v[42:43], s[4:5]
    v_pk_mul_f32 v[44:45], v[44:45], s[4:5]
    v_pk_mul_f32 v[46:47], v[46:47], s[4:5]
    v_cvt_pk_bf16_f32 v48, v32, v33
    v_cvt_pk_bf16_f32 v49, v34, v35
    v_cvt_pk_bf16_f32 v50, v36, v37
    v_cvt_pk_bf16_f32 v51, v38, v39
    v_cvt_pk_bf16_f32 v52, v40, v41
    v_cvt_pk_bf16_f32 v53, v42, v43
    v_cvt_pk_bf16_f32 v54, v44, v45
    v_cvt_pk_bf16_f32 v55, v46, v47
    v_add_u32 v16, 61696, v8
    ds_write_b128 v16, v[48:51]
    v_lshlrev_b32 v56, 16, v52
    v_and_b32 v57, 0xffff0000, v52
    v_lshlrev_b32 v58, 16, v53
    v_and_b32 v59, 0xffff0000, v53
    v_lshlrev_b32 v60, 16, v54
    v_and_b32 v61, 0xffff0000, v54
    v_lshlrev_b32 v62, 16, v55
    v_and_b32 v63, 0xffff0000, v55
    v_pk_add_f32 v[56:57], v[40:41], v[56:57] neg_lo:[0,1] neg_hi:[0,1]
    v_pk_add_f32 v[58:59], v[42:43], v[58:59] neg_lo:[0,1] neg_hi:[0,1]
    v_pk_add_f32 v[60:61], v[44:45], v[60:61] neg_lo:[0,1] neg_hi:[0,1]
    v_pk_add_f32 v[62:63], v[46:47], v[62:63] neg_lo:[0,1] neg_hi:[0,1]
    v_cvt_pk_bf16_f32 v56, v56, v57
    v_cvt_pk_bf16_f32 v57, v58, v59
    v_cvt_pk_bf16_f32 v58, v60, v61
    v_cvt_pk_bf16_f32 v59, v62, v63
    v_add_u32 v16, 77952, v11
    v_add_u32 v17, 78592, v11
    s_mov_b64 exec, 0xff
    ds_write_b128 v17, v[52:55]
    ds_write_b128 v17, v[56:59] offset:128
    s_mov_b32 s6, 0xffffff00
    s_mov_b32 s7, 0xff0000ff
    s_mov_b64 exec, s[6:7]
    ds_write_b128 v16, v[52:55]
    s_mov_b32 s6, 0
    s_mov_b32 s7, 0xff000000
    s_mov_b64 exec, s[6:7]
    ds_write_b128 v16, v[52:55] offset:128
    s_mov_b64 exec, -1
    v_bfe_u32 v18, v1, 2, 2
    v_lshlrev_b32 v16, 7, v18
    v_bfe_u32 v18, v1, 4, 1
    v_lshl_add_u32 v16, v18, 5, v16
    v_and_b32 v18, 3, v1
    v_lshl_add_u32 v16, v18, 3, v16
    v_add_u32 v244, 78080, v16
    v_lshl_add_u32 v16, v10, 10, v16
    v_add_u32 v245, 61696, v16
    s_mov_b32 s5, 200000
    s_memrealtime s[6:7]
    s_waitcnt lgkmcnt(0)
K_EPW:
    v_readfirstlane_b32 s4, v160
    s_nop 0
    s_sub_u32 s7, s6, s4
    s_add_u32 s7, s7, 100000
    s_cmp_eq_u32 s4, 0
    s_cselect_b32 s7, -1, s7
    s_cmp_lt_u32 s7, 200000
    s_cbranch_scc1 K_EPOK
    s_cmp_eq_u32 s4, 0
    s_cselect_b32 s7, 1, 64
    s_sub_u32 s5, s5, s7
    s_cbranch_scc1 K_EPOK
    buffer_load_dword v160, v250, s[28:31], 0 offen sc0 sc1
    s_waitcnt vmcnt(0)
    s_branch K_EPW
K_EPOK:
    s_add_u32 s28, s52, 0x1000000
    s_addc_u32 s29, s53, 0
    s_mov_b32 s30, 0x2000000
    s_mov_b32 s31, 0x20000
    v_mov_b32 v77, v160
    s_lshl_b32 s3, s2, 12
    s_add_u32 s3, s3, 0xa00000
    v_lshlrev_b32 v15, 2, v15
    s_mov_b32 s4, 0x9e3779b9
    v_not_b32 v79, v77
    v_xor_b32 v234, s4, v77
    v_xor_b32 v78, v76, v234
    v_mov_b32 v232, v77
    v_mov_b32 v233, v79
    v_lshlrev_b32 v246, 12, v9
    s_lshl_b32 s5, s64, 17
    s_lshl_b32 s6, s65, 4
    s_add_u32 s5, s5, s6
    s_add_u32 s92, s5, 0xa00000
    s_waitcnt vmcnt(0) lgkmcnt(0)
    s_barrier
    s_cmp_ge_u32 s64, 4
    s_cbranch_scc1 K_NOPUB
    buffer_store_dwordx4 v[76:79], v15, s[16:19], s3 offen sc1
K_NOPUB:
    ds_read_b64_tr_b16 v[180:181], v245 offset:8192
    ds_read_b64_tr_b16 v[182:183], v245 offset:8704
    ds_read_b64_tr_b16 v[184:185], v245 offset:10240
    ds_read_b64_tr_b16 v[186:187], v245 offset:10752
    ds_read_b64_tr_b16 v[188:189], v245 offset:12288
    ds_read_b64_tr_b16 v[190:191], v245 offset:12800
    ds_read_b64_tr_b16 v[192:193], v245 offset:14336
    ds_read_b64_tr_b16 v[194:195], v245 offset:14848
    ds_read_b64_tr_b16 v[196:197], v245 offset:8256
    ds_read_b64_tr_b16 v[198:199], v245 offset:8768
    ds_read_b64_tr_b16 v[200:201], v245 offset:10304
    ds_read_b64_tr_b16 v[202:203], v245 offset:10816
    ds_read_b64_tr_b16 v[204:205], v245 offset:12352
    ds_read_b64_tr_b16 v[206:207], v245 offset:12864
    ds_read_b64_tr_b16 v[208:209], v245 offset:14400
    ds_read_b64_tr_b16 v[210:211], v245 offset:14912
    s_waitcnt lgkmcnt(8)
    v_mfma_f32_32x32x16_bf16 v[148:163], v[80:83], v[180:183], 0
    v_mfma_f32_32x32x16_bf16 v[148:163], v[84:87], v[184:187], v[148:163]
    v_mfma_f32_32x32x16_bf16 v[148:163], v[88:91], v[188:191], v[148:163]
    v_mfma_f32_32x32x16_bf16 v[148:163], v[92:95], v[192:195], v[148:163]
    ds_read_b64_tr_b16 v[132:133], v244 offset:0
    ds_read_b64_tr_b16 v[134:135], v244 offset:512
    ds_read_b64_tr_b16 v[136:137], v244 offset:64
    ds_read_b64_tr_b16 v[138:139], v244 offset:576
    ds_read_b64_tr_b16 v[140:141], v244 offset:0
    ds_read_b64_tr_b16 v[142:143], v244 offset:512
    ds_read_b64_tr_b16 v[144:145], v244 offset:64
    ds_read_b64_tr_b16 v[146:147], v244 offset:576
    s_waitcnt lgkmcnt(8)
    v_mfma_f32_32x32x16_bf16 v[164:179], v[80:83], v[196:199], 0
    v_mfma_f32_32x32x16_bf16 v[164:179], v[84:87], v[200:203], v[164:179]
    v_mfma_f32_32x32x16_bf16 v[164:179], v[88:91], v[204:207], v[164:179]
    v_mfma_f32_32x32x16_bf16 v[164:179], v[92:95], v[208:211], v[164:179]
    s_waitcnt lgkmcnt(0)
    ds_read_b64_tr_b16 v[100:101], v245 offset:0
    ds_read_b64_tr_b16 v[102:103], v245 offset:512
    ds_read_b64_tr_b16 v[104:105], v245 offset:2048
    ds_read_b64_tr_b16 v[106:107], v245 offset:2560
    ds_read_b64_tr_b16 v[108:109], v245 offset:4096
    ds_read_b64_tr_b16 v[110:111], v245 offset:4608
    ds_read_b64_tr_b16 v[112:113], v245 offset:6144
    ds_read_b64_tr_b16 v[114:115], v245 offset:6656
    ds_read_b64_tr_b16 v[116:117], v245 offset:64
    ds_read_b64_tr_b16 v[118:119], v245 offset:576
    ds_read_b64_tr_b16 v[120:121], v245 offset:2112
    ds_read_b64_tr_b16 v[122:123], v245 offset:2624
    ds_read_b64_tr_b16 v[124:125], v245 offset:4160
    ds_read_b64_tr_b16 v[126:127], v245 offset:4672
    ds_read_b64_tr_b16 v[128:129], v245 offset:6208
    ds_read_b64_tr_b16 v[130:131], v245 offset:6720
    s_mov_b32 s4, 0xbfb8aa3b
    s_mov_b32 s5, s4
    s_mov_b64 exec, s[70:71]
    v_pk_mul_f32 v[148:149], v[148:149], s[4:5]
    v_pk_mul_f32 v[150:151], v[150:151], s[4:5]
    v_pk_mul_f32 v[152:153], v[152:153], s[4:5]
    v_pk_mul_f32 v[154:155], v[154:155], s[4:5]
    v_pk_mul_f32 v[156:157], v[156:157], s[4:5]
    v_pk_mul_f32 v[158:159], v[158:159], s[4:5]
    v_pk_mul_f32 v[160:161], v[160:161], s[4:5]
    v_pk_mul_f32 v[162:163], v[162:163], s[4:5]
    v_cvt_pk_bf16_f32 v132, v148, v149
    v_cvt_pk_bf16_f32 v140, v156, v157
    v_cvt_pk_bf16_f32 v133, v150, v151
    v_cvt_pk_bf16_f32 v141, v158, v159
    v_cvt_pk_bf16_f32 v134, v152, v153
    v_cvt_pk_bf16_f32 v142, v160, v161
    v_cvt_pk_bf16_f32 v135, v154, v155
    v_cvt_pk_bf16_f32 v143, v162, v163
    v_pk_mul_f32 v[164:165], v[164:165], s[4:5]
    v_pk_mul_f32 v[166:167], v[166:167], s[4:5]
    v_pk_mul_f32 v[168:169], v[168:169], s[4:5]
    v_pk_mul_f32 v[170:171], v[170:171], s[4:5]
    v_pk_mul_f32 v[172:173], v[172:173], s[4:5]
    v_pk_mul_f32 v[174:175], v[174:175], s[4:5]
    v_pk_mul_f32 v[176:177], v[176:177], s[4:5]
    v_pk_mul_f32 v[178:179], v[178:179], s[4:5]
    v_cvt_pk_bf16_f32 v136, v164, v165
    v_cvt_pk_bf16_f32 v144, v172, v173
    v_cvt_pk_bf16_f32 v137, v166, v167
    v_cvt_pk_bf16_f32 v145, v174, v175
    v_cvt_pk_bf16_f32 v138, v168, v169
    v_cvt_pk_bf16_f32 v146, v176, v177
    v_cvt_pk_bf16_f32 v139, v170, v171
    v_cvt_pk_bf16_f32 v147, v178, v179
    s_mov_b64 exec, -1
    v_mov_b32 v148, 0
    v_mov_b32 v149, 0
    v_mov_b32 v150, 0
    v_mov_b32 v151, 0
    v_mov_b32 v152, 0
    v_mov_b32 v153, 0
    v_mov_b32 v154, 0
    v_mov_b32 v155, 0
    v_mov_b32 v156, 0
    v_mov_b32 v157, 0
    v_mov_b32 v158, 0
    v_mov_b32 v159, 0
    v_mov_b32 v160, 0
    v_mov_b32 v161, 0
    v_mov_b32 v162, 0
    v_mov_b32 v163, 0
    v_mov_b32 v164, 0
    v_mov_b32 v165, 0
    v_mov_b32 v166, 0
    v_mov_b32 v167, 0
    v_mov_b32 v168, 0
    v_mov_b32 v169, 0
    v_mov_b32 v170, 0
    v_mov_b32 v171, 0
    v_mov_b32 v172, 0
    v_mov_b32 v173, 0
    v_mov_b32 v174, 0
    v_mov_b32 v175, 0
    v_mov_b32 v176, 0
    v_mov_b32 v177, 0
    v_mov_b32 v178, 0
    v_mov_b32 v179, 0
    v_mov_b32 v180, 0
    v_mov_b32 v181, 0
    v_mov_b32 v182, 0
    v_mov_b32 v183, 0
    v_mov_b32 v184, 0
    v_mov_b32 v185, 0
    v_mov_b32 v186, 0
    v_mov_b32 v187, 0
    v_mov_b32 v188, 0
    v_mov_b32 v189, 0
    v_mov_b32 v190, 0
    v_mov_b32 v191, 0
    v_mov_b32 v192, 0
    v_mov_b32 v193, 0
    v_mov_b32 v194, 0
    v_mov_b32 v195, 0
    v_mov_b32 v196, 0
    v_mov_b32 v197, 0
    v_mov_b32 v198, 0
    v_mov_b32 v199, 0
    v_mov_b32 v200, 0
    v_mov_b32 v201, 0
    v_mov_b32 v202, 0
    v_mov_b32 v203, 0
    v_mov_b32 v204, 0
    v_mov_b32 v205, 0
    v_mov_b32 v206, 0
    v_mov_b32 v207, 0
    v_mov_b32 v208, 0
    v_mov_b32 v209, 0
    v_mov_b32 v210, 0
    v_mov_b32 v211, 0
    v_and_b32 v12, 7, v1
    v_and_b32 v13, 8, v1
    v_cmp_eq_u32 vcc, 0, v13
    v_mov_b32 v13, s67
    v_mov_b32 v14, s66
    v_cndmask_b32 v13, v13, v14, vcc
    v_mov_b32 v14, s69
    v_mov_b32 v15, s68
    v_cndmask_b32 v14, v14, v15, vcc
    v_cmp_lt_u32 vcc, v12, v14
    v_add_u32 v13, v13, v12
    v_lshlrev_b32 v13, 7, v13
    v_lshrrev_b32 v14, 4, v1
    v_lshl_add_u32 v13, v14, 5, v13
    v_mov_b32 v15, 0x40000000
    v_cndmask_b32 v236, v15, v13, vcc
    v_bfe_u32 v12, v1, 2, 2
    v_lshrrev_b32 v13, 5, v1
    v_lshl_add_u32 v12, v12, 1, v13
    v_and_b32 v13, 16, v1
    v_cmp_eq_u32 vcc, 0, v13
    v_mov_b32 v13, s67
    v_mov_b32 v14, s66
    v_cndmask_b32 v13, v13, v14, vcc
    v_mov_b32 v14, s69
    v_mov_b32 v15, s68
    v_cndmask_b32 v14, v14, v15, vcc
    v_cmp_lt_u32 vcc, v12, v14
    v_add_u32 v13, v13, v12
    v_mul_u32_u24 v13, 6, v13
    v_and_b32 v14, 3, v1
    v_lshl_add_u32 v13, v14, 1, v13
    v_cmp_gt_u32 s[90:91], 3, v14
    v_mov_b32 v15, 0x40000000
    s_and_b64 vcc, vcc, s[90:91]
    v_cndmask_b32 v237, v15, v13, vcc
    buffer_load_dwordx4 v[8:11], v236, s[8:11], 0 offen
    buffer_load_dwordx4 v[12:15], v236, s[8:11], 0 offen offset:16
    v_lshrrev_b32 v16, 1, v223
    buffer_load_ushort v252, v16, s[96:99], 0 offen
    buffer_load_ushort v254, v16, s[96:99], 0 offen offset:64
    buffer_load_ushort v238, v237, s[20:23], 0 offen
    v_mov_b32 v2, 0
    v_mov_b32 v0, 0
    v_mov_b32 v247, 0
    s_mov_b32 s78, -1
    s_mov_b32 s79, 0
    s_mov_b32 s80, 0
    s_mov_b32 s101, 200000
    s_mov_b32 s100, 0
    s_waitcnt lgkmcnt(0)
    s_barrier
K_POLL:
    s_mov_b64 exec, s[78:79]
    buffer_load_dwordx4 v[240:243], v246, s[16:19], s92 offen sc1
    s_waitcnt vmcnt(0)
    v_xor_b32 v242, v240, v242
    v_cmp_eq_u32 vcc, v241, v232
    v_cmp_eq_u32 s[60:61], v243, v233
    v_cmp_eq_u32 s[58:59], v242, v234
    s_and_b64 vcc, vcc, s[60:61]
    s_and_b64 vcc, vcc, s[58:59]
    v_cndmask_b32 v2, v2, v240, vcc
    v_cndmask_b32 v0, v0, v240, vcc
    s_mov_b64 exec, -1
    s_andn2_b32 s78, s78, vcc_lo
    s_cbranch_scc0 K_ALLIN
    s_bcnt1_i32_b32 s4, s78
    s_cmp_le_u32 s4, 0
    s_cbranch_scc0 K_PWAIT
    v_cmp_ne_u32 vcc, 0, v0
    s_nop 0
    s_cmp_lg_u32 vcc_lo, 0
    s_cbranch_scc1 K_ROUND
K_PWAIT:
    s_sub_u32 s101, s101, 1
    s_cmp_eq_u32 s101, 0
    s_cselect_b32 s78, 0, s78
    s_cbranch_scc1 K_ALLIN
    s_branch K_POLL
K_ALLIN:
    v_mov_b32 v243, v252
    s_branch K_ROUND
K_RESET:
    s_mov_b32 s101, -1
    v_lshlrev_b32 v249, 2, v1
    s_mov_b64 exec, 0x1ffff
    ds_write_b32 v249, v235
    s_mov_b64 exec, -1
    v_mov_b32 v0, v2
    s_mov_b32 s100, 1
    s_waitcnt lgkmcnt(0)
    s_barrier
K_ROUND:
    ds_bpermute_b32 v19, v5, v0 offset:0
    ds_bpermute_b32 v23, v5, v0 offset:8
    ds_bpermute_b32 v27, v5, v0 offset:16
    ds_bpermute_b32 v31, v5, v0 offset:24
    ds_bpermute_b32 v35, v5, v0 offset:32
    ds_bpermute_b32 v39, v5, v0 offset:40
    ds_bpermute_b32 v43, v5, v0 offset:48
    ds_bpermute_b32 v47, v5, v0 offset:56
    ds_bpermute_b32 v51, v5, v0 offset:64
    ds_bpermute_b32 v55, v5, v0 offset:72
    ds_bpermute_b32 v59, v5, v0 offset:80
    ds_bpermute_b32 v63, v5, v0 offset:88
    ds_bpermute_b32 v67, v5, v0 offset:96
    ds_bpermute_b32 v71, v5, v0 offset:104
    ds_bpermute_b32 v75, v5, v0 offset:112
    ds_bpermute_b32 v79, v5, v0 offset:120
    s_mov_b32 s3, s93
    s_waitcnt lgkmcnt(15)
    v_cmp_lt_u32_sdwa s[32:33], v3, v19 src0_sel:DWORD src1_sel:WORD_1
    v_add_u32_sdwa v19, v19, v4 dst_sel:DWORD dst_unused:UNUSED_PAD src0_sel:WORD_0 src1_sel:DWORD
    s_or_b64 exec, s[32:33], 1
    buffer_load_dwordx3 v[16:18], v19, s[16:19], s3 offen sc1
    s_mov_b64 exec, -1
    s_add_u32 s3, s3, 75264
    s_waitcnt lgkmcnt(14)
    v_cmp_lt_u32_sdwa s[34:35], v3, v23 src0_sel:DWORD src1_sel:WORD_1
    v_add_u32_sdwa v23, v23, v4 dst_sel:DWORD dst_unused:UNUSED_PAD src0_sel:WORD_0 src1_sel:DWORD
    s_or_b64 exec, s[34:35], 1
    buffer_load_dwordx3 v[20:22], v23, s[16:19], s3 offen sc1
    s_mov_b64 exec, -1
    s_add_u32 s3, s3, 75264
    s_waitcnt lgkmcnt(13)
    v_cmp_lt_u32_sdwa s[36:37], v3, v27 src0_sel:DWORD src1_sel:WORD_1
    v_add_u32_sdwa v27, v27, v4 dst_sel:DWORD dst_unused:UNUSED_PAD src0_sel:WORD_0 src1_sel:DWORD
    s_or_b64 exec, s[36:37], 1
    buffer_load_dwordx3 v[24:26], v27, s[16:19], s3 offen sc1
    s_mov_b64 exec, -1
    s_add_u32 s3, s3, 75264
    s_waitcnt lgkmcnt(12)
    v_cmp_lt_u32_sdwa s[38:39], v3, v31 src0_sel:DWORD src1_sel:WORD_1
    v_add_u32_sdwa v31, v31, v4 dst_sel:DWORD dst_unused:UNUSED_PAD src0_sel:WORD_0 src1_sel:DWORD
    s_or_b64 exec, s[38:39], 1
    buffer_load_dwordx3 v[28:30], v31, s[16:19], s3 offen sc1
    s_mov_b64 exec, -1
    s_add_u32 s3, s3, 75264
    s_waitcnt lgkmcnt(11)
    v_cmp_lt_u32_sdwa s[40:41], v3, v35 src0_sel:DWORD src1_sel:WORD_1
    v_add_u32_sdwa v35, v35, v4 dst_sel:DWORD dst_unused:UNUSED_PAD src0_sel:WORD_0 src1_sel:DWORD
    s_or_b64 exec, s[40:41], 1
    buffer_load_dwordx3 v[32:34], v35, s[16:19], s3 offen sc1
    s_mov_b64 exec, -1
    s_add_u32 s3, s3, 75264
    s_waitcnt lgkmcnt(10)
    v_cmp_lt_u32_sdwa s[42:43], v3, v39 src0_sel:DWORD src1_sel:WORD_1
    v_add_u32_sdwa v39, v39, v4 dst_sel:DWORD dst_unused:UNUSED_PAD src0_sel:WORD_0 src1_sel:DWORD
    s_or_b64 exec, s[42:43], 1
    buffer_load_dwordx3 v[36:38], v39, s[16:19], s3 offen sc1
    s_mov_b64 exec, -1
    s_add_u32 s3, s3, 75264
    s_waitcnt lgkmcnt(9)
    v_cmp_lt_u32_sdwa s[44:45], v3, v43 src0_sel:DWORD src1_sel:WORD_1
    v_add_u32_sdwa v43, v43, v4 dst_sel:DWORD dst_unused:UNUSED_PAD src0_sel:WORD_0 src1_sel:DWORD
    s_or_b64 exec, s[44:45], 1
    buffer_load_dwordx3 v[40:42], v43, s[16:19], s3 offen sc1
    s_mov_b64 exec, -1
    s_add_u32 s3, s3, 75264
    s_waitcnt lgkmcnt(8)
    v_cmp_lt_u32_sdwa s[46:47], v3, v47 src0_sel:DWORD src1_sel:WORD_1
    v_add_u32_sdwa v47, v47, v4 dst_sel:DWORD dst_unused:UNUSED_PAD src0_sel:WORD_0 src1_sel:DWORD
    s_or_b64 exec, s[46:47], 1
    buffer_load_dwordx3 v[44:46], v47, s[16:19], s3 offen sc1
    s_mov_b64 exec, -1
    s_add_u32 s3, s3, 75264
    s_waitcnt lgkmcnt(7)
    v_cmp_lt_u32_sdwa s[48:49], v3, v51 src0_sel:DWORD src1_sel:WORD_1
    v_add_u32_sdwa v51, v51, v4 dst_sel:DWORD dst_unused:UNUSED_PAD src0_sel:WORD_0 src1_sel:DWORD
    s_or_b64 exec, s[48:49], 1
    buffer_load_dwordx3 v[48:50], v51, s[16:19], s3 offen sc1
    s_mov_b64 exec, -1
    s_add_u32 s3, s3, 75264
    s_waitcnt lgkmcnt(6)
    v_cmp_lt_u32_sdwa s[50:51], v3, v55 src0_sel:DWORD src1_sel:WORD_1
    v_add_u32_sdwa v55, v55, v4 dst_sel:DWORD dst_unused:UNUSED_PAD src0_sel:WORD_0 src1_sel:DWORD
    s_or_b64 exec, s[50:51], 1
    buffer_load_dwordx3 v[52:54], v55, s[16:19], s3 offen sc1
    s_mov_b64 exec, -1
    s_add_u32 s3, s3, 75264
    s_waitcnt lgkmcnt(5)
    v_cmp_lt_u32_sdwa s[52:53], v3, v59 src0_sel:DWORD src1_sel:WORD_1
    v_add_u32_sdwa v59, v59, v4 dst_sel:DWORD dst_unused:UNUSED_PAD src0_sel:WORD_0 src1_sel:DWORD
    s_or_b64 exec, s[52:53], 1
    buffer_load_dwordx3 v[56:58], v59, s[16:19], s3 offen sc1
    s_mov_b64 exec, -1
    s_add_u32 s3, s3, 75264
    s_waitcnt lgkmcnt(4)
    v_cmp_lt_u32_sdwa s[54:55], v3, v63 src0_sel:DWORD src1_sel:WORD_1
    v_add_u32_sdwa v63, v63, v4 dst_sel:DWORD dst_unused:UNUSED_PAD src0_sel:WORD_0 src1_sel:DWORD
    s_or_b64 exec, s[54:55], 1
    buffer_load_dwordx3 v[60:62], v63, s[16:19], s3 offen sc1
    s_mov_b64 exec, -1
    s_add_u32 s3, s3, 75264
    s_waitcnt lgkmcnt(3)
    v_cmp_lt_u32_sdwa s[56:57], v3, v67 src0_sel:DWORD src1_sel:WORD_1
    v_add_u32_sdwa v67, v67, v4 dst_sel:DWORD dst_unused:UNUSED_PAD src0_sel:WORD_0 src1_sel:DWORD
    s_or_b64 exec, s[56:57], 1
    buffer_load_dwordx3 v[64:66], v67, s[16:19], s3 offen sc1
    s_mov_b64 exec, -1
    s_add_u32 s3, s3, 75264
    s_waitcnt lgkmcnt(2)
    v_cmp_lt_u32_sdwa s[58:59], v3, v71 src0_sel:DWORD src1_sel:WORD_1
    v_add_u32_sdwa v71, v71, v4 dst_sel:DWORD dst_unused:UNUSED_PAD src0_sel:WORD_0 src1_sel:DWORD
    s_or_b64 exec, s[58:59], 1
    buffer_load_dwordx3 v[68:70], v71, s[16:19], s3 offen sc1
    s_mov_b64 exec, -1
    s_add_u32 s3, s3, 75264
    s_waitcnt lgkmcnt(1)
    v_cmp_lt_u32_sdwa s[60:61], v3, v75 src0_sel:DWORD src1_sel:WORD_1
    v_add_u32_sdwa v75, v75, v4 dst_sel:DWORD dst_unused:UNUSED_PAD src0_sel:WORD_0 src1_sel:DWORD
    s_or_b64 exec, s[60:61], 1
    buffer_load_dwordx3 v[72:74], v75, s[16:19], s3 offen sc1
    s_mov_b64 exec, -1
    s_add_u32 s3, s3, 75264
    s_waitcnt lgkmcnt(0)
    v_cmp_lt_u32_sdwa s[62:63], v3, v79 src0_sel:DWORD src1_sel:WORD_1
    v_add_u32_sdwa v79, v79, v4 dst_sel:DWORD dst_unused:UNUSED_PAD src0_sel:WORD_0 src1_sel:DWORD
    s_or_b64 exec, s[62:63], 1
    buffer_load_dwordx3 v[76:78], v79, s[16:19], s3 offen sc1
    s_mov_b64 exec, -1
    s_add_u32 s3, s3, 75264
    v_lshrrev_b32 v249, 16, v0
    v_cmp_lt_u32 vcc, s87, v249
    v_min_u32 v249, s87, v249
    v_add_u32 v0, v0, v249
    v_lshlrev_b32 v249, 16, v249
    v_sub_u32 v0, v0, v249
    s_mov_b32 s89, vcc_lo
    v_cndmask_b32 v247, v247, v0, vcc
    s_waitcnt vmcnt(15)
    s_mov_b64 exec, s[32:33]
    v_bfe_u32 v19, v18, 22, 6
    ds_add_rtn_u32 v19, v19, v6
    s_waitcnt vmcnt(14)
    s_mov_b64 exec, s[34:35]
    v_bfe_u32 v23, v22, 22, 6
    ds_add_rtn_u32 v23, v23, v6
    s_waitcnt vmcnt(13)
    s_mov_b64 exec, s[36:37]
    v_bfe_u32 v27, v26, 22, 6
    ds_add_rtn_u32 v27, v27, v6
    s_waitcnt vmcnt(12)
    s_mov_b64 exec, s[38:39]
    v_bfe_u32 v31, v30, 22, 6
    ds_add_rtn_u32 v31, v31, v6
    s_waitcnt lgkmcnt(0)
    s_mov_b64 exec, s[32:33]
    ds_write_b32 v19, v18
    ds_write2st64_b32 v19, v16, v17 offset0:74 offset1:148
    s_mov_b64 exec, s[34:35]
    ds_write_b32 v23, v22
    ds_write2st64_b32 v23, v20, v21 offset0:74 offset1:148
    s_mov_b64 exec, s[36:37]
    ds_write_b32 v27, v26
    ds_write2st64_b32 v27, v24, v25 offset0:74 offset1:148
    s_mov_b64 exec, s[38:39]
    ds_write_b32 v31, v30
    ds_write2st64_b32 v31, v28, v29 offset0:74 offset1:148
    s_waitcnt vmcnt(11)
    s_mov_b64 exec, s[40:41]
    v_bfe_u32 v35, v34, 22, 6
    ds_add_rtn_u32 v35, v35, v6
    s_waitcnt vmcnt(10)
    s_mov_b64 exec, s[42:43]
    v_bfe_u32 v39, v38, 22, 6
    ds_add_rtn_u32 v39, v39, v6
    s_waitcnt vmcnt(9)
    s_mov_b64 exec, s[44:45]
    v_bfe_u32 v43, v42, 22, 6
    ds_add_rtn_u32 v43, v43, v6
    s_waitcnt vmcnt(8)
    s_mov_b64 exec, s[46:47]
    v_bfe_u32 v47, v46, 22, 6
    ds_add_rtn_u32 v47, v47, v6
    s_waitcnt lgkmcnt(0)
    s_mov_b64 exec, s[40:41]
    ds_write_b32 v35, v34
    ds_write2st64_b32 v35, v32, v33 offset0:74 offset1:148
    s_mov_b64 exec, s[42:43]
    ds_write_b32 v39, v38
    ds_write2st64_b32 v39, v36, v37 offset0:74 offset1:148
    s_mov_b64 exec, s[44:45]
    ds_write_b32 v43, v42
    ds_write2st64_b32 v43, v40, v41 offset0:74 offset1:148
    s_mov_b64 exec, s[46:47]
    ds_write_b32 v47, v46
    ds_write2st64_b32 v47, v44, v45 offset0:74 offset1:148
    s_waitcnt vmcnt(7)
    s_mov_b64 exec, s[48:49]
    v_bfe_u32 v51, v50, 22, 6
    ds_add_rtn_u32 v51, v51, v6
    s_waitcnt vmcnt(6)
    s_mov_b64 exec, s[50:51]
    v_bfe_u32 v55, v54, 22, 6
    ds_add_rtn_u32 v55, v55, v6
    s_waitcnt vmcnt(5)
    s_mov_b64 exec, s[52:53]
    v_bfe_u32 v59, v58, 22, 6
    ds_add_rtn_u32 v59, v59, v6
    s_waitcnt vmcnt(4)
    s_mov_b64 exec, s[54:55]
    v_bfe_u32 v63, v62, 22, 6
    ds_add_rtn_u32 v63, v63, v6
    s_waitcnt lgkmcnt(0)
    s_mov_b64 exec, s[48:49]
    ds_write_b32 v51, v50
    ds_write2st64_b32 v51, v48, v49 offset0:74 offset1:148
    s_mov_b64 exec, s[50:51]
    ds_write_b32 v55, v54
    ds_write2st64_b32 v55, v52, v53 offset0:74 offset1:148
    s_mov_b64 exec, s[52:53]
    ds_write_b32 v59, v58
    ds_write2st64_b32 v59, v56, v57 offset0:74 offset1:148
    s_mov_b64 exec, s[54:55]
    ds_write_b32 v63, v62
    ds_write2st64_b32 v63, v60, v61 offset0:74 offset1:148
    s_waitcnt vmcnt(3)
    s_mov_b64 exec, s[56:57]
    v_bfe_u32 v67, v66, 22, 6
    ds_add_rtn_u32 v67, v67, v6
    s_waitcnt vmcnt(2)
    s_mov_b64 exec, s[58:59]
    v_bfe_u32 v71, v70, 22, 6
    ds_add_rtn_u32 v71, v71, v6
    s_waitcnt vmcnt(1)
    s_mov_b64 exec, s[60:61]
    v_bfe_u32 v75, v74, 22, 6
    ds_add_rtn_u32 v75, v75, v6
    s_waitcnt vmcnt(0)
    s_mov_b64 exec, s[62:63]
    v_bfe_u32 v79, v78, 22, 6
    ds_add_rtn_u32 v79, v79, v6
    s_waitcnt lgkmcnt(0)
    s_mov_b64 exec, s[56:57]
    ds_write_b32 v67, v66
    ds_write2st64_b32 v67, v64, v65 offset0:74 offset1:148
    s_mov_b64 exec, s[58:59]
    ds_write_b32 v71, v70
    ds_write2st64_b32 v71, v68, v69 offset0:74 offset1:148
    s_mov_b64 exec, s[60:61]
    ds_write_b32 v75, v74
    ds_write2st64_b32 v75, v72, v73 offset0:74 offset1:148
    s_mov_b64 exec, s[62:63]
    ds_write_b32 v79, v78
    ds_write2st64_b32 v79, v76, v77 offset0:74 offset1:148
    s_mov_b64 exec, -1
    s_cmp_lg_u32 s100, 0
    s_cbranch_scc1 K_LAST
    s_or_b32 s80, s80, s89
    v_mov_b32 v0, 0
    s_cmp_lg_u32 s78, 0
    s_cbranch_scc1 K_POLL
    s_cmp_eq_u32 s80, 0
    s_cbranch_scc1 K_BINNED
    v_mov_b32 v0, v247
    s_mov_b32 s100, 1
    s_branch K_ROUND
K_LAST:
    s_cmp_eq_u32 s89, 0
    s_cbranch_scc1 K_BINNED
    v_mov_b32 v249, 64
    ds_write_b32 v249, v6
K_BINNED:
    s_mov_b32 s32, s8
    s_mov_b32 s33, s9
    s_mov_b32 s34, 0x30d400
    s_mov_b32 s35, 0x20000
    s_sub_u32 s36, s8, 0x400
    s_subb_u32 s37, s9, 0
    s_mov_b32 s38, 0x30d800
    s_mov_b32 s39, 0x20000
    s_sub_u32 s40, s8, 0x800
    s_subb_u32 s41, s9, 0
    s_mov_b32 s42, 0x30dc00
    s_mov_b32 s43, 0x20000
    s_sub_u32 s44, s8, 0xc00
    s_subb_u32 s45, s9, 0
    s_mov_b32 s46, 0x30e000
    s_mov_b32 s47, 0x20000
    v_mov_b32 v64, 0
    v_mov_b32 v65, 0
    v_mov_b32 v66, 0
    v_mov_b32 v67, 0
    v_mov_b32 v68, 0
    v_mov_b32 v69, 0
    v_mov_b32 v70, 0
    v_mov_b32 v71, 0
    v_mov_b32 v72, 0
    v_mov_b32 v73, 0
    v_mov_b32 v74, 0
    v_mov_b32 v75, 0
    v_mov_b32 v76, 0
    v_mov_b32 v77, 0
    v_mov_b32 v78, 0
    v_mov_b32 v79, 0
    v_lshlrev_b32 v17, 2, v1
    s_mov_b32 s4, s64
    s_add_u32 s5, s4, 8
    s_xor_b32 s48, s4, 4
    s_xor_b32 s49, s5, 4
    v_readlane_b32 s78, v235, s4
    v_readlane_b32 s80, v235, s5
    v_mov_b32 v19, 0x3fffb8
    s_mov_b32 s75, s76
    s_mov_b32 s57, 0
    s_cmp_lg_u32 s101, -1
    s_cbranch_scc0 K_NOEARLY
    v_add_u32 v18, s78, v17
    ds_read_b32 v16, v18
    v_add_u32 v249, s78, v222
    v_add_u32 v230, s78, v223
    v_add_u32 v231, 128, v230
    ds_read_b128 v[20:23], v249
    ds_read_b32 v228, v230
    ds_read_b128 v[224:227], v249 offset:128
    ds_read_b32 v229, v231
    s_waitcnt lgkmcnt(4)
    v_cmp_ne_u32 vcc, -1, v16
    s_nop 0
    s_cmp_eq_u64 vcc, -1
    s_cbranch_scc0 K_NOEARLY
    s_mov_b32 s57, 1
    s_waitcnt lgkmcnt(0)
    v_and_or_b32 v20, v20, s74, v212
    v_and_or_b32 v21, v21, s74, v213
    v_and_or_b32 v22, v22, s74, v214
    v_and_or_b32 v23, v23, s74, v215
    s_add_u32 m0, s86, 0
    s_nop 0
    buffer_load_dwordx4 v20, s[32:35], 0 offen offset:0  lds
    buffer_load_dwordx4 v21, s[36:39], 0 offen offset:1024  lds
    buffer_load_dwordx4 v22, s[40:43], 0 offen offset:2048  lds
    buffer_load_dwordx4 v23, s[44:47], 0 offen offset:3072  lds
    v_bfe_u32 v253, v228, 7, 15
    v_mul_u32_u24 v253, 6, v253
    v_mov_b32 v232, 0
    v_mov_b32 v233, 0
    v_mov_b32 v234, 0
    s_mov_b64 exec, s[72:73]
    buffer_load_short_d16_hi v232, v253, s[20:23], 0 offen offset:0
    buffer_load_short_d16_hi v233, v253, s[20:23], 0 offen offset:2
    buffer_load_short_d16_hi v234, v253, s[20:23], 0 offen offset:4
    s_mov_b64 exec, -1
    v_and_or_b32 v224, v224, s74, v212
    v_and_or_b32 v225, v225, s74, v213
    v_and_or_b32 v226, v226, s74, v214
    v_and_or_b32 v227, v227, s74, v215
    s_add_u32 m0, s86, 4096
    s_nop 0
    buffer_load_dwordx4 v224, s[32:35], 0 offen offset:0  lds
    buffer_load_dwordx4 v225, s[36:39], 0 offen offset:1024  lds
    buffer_load_dwordx4 v226, s[40:43], 0 offen offset:2048  lds
    buffer_load_dwordx4 v227, s[44:47], 0 offen offset:3072  lds
K_NOEARLY:
    s_waitcnt lgkmcnt(0)
    s_barrier
    ds_read_b32 v16, v17
    s_waitcnt lgkmcnt(0)
    v_cmp_gt_u32 vcc, v16, v239
    v_sub_u32 v18, v16, v235
    v_add_u32 v18, 127, v18
    v_lshrrev_b32 v18, 7, v18
    v_med3_u32 v18, v18, 1, 10
    v_sub_u32 v24, v16, v235
    v_add_u32 v24, 64, v24
    v_lshrrev_b32 v24, 5, v24
    v_readlane_b32 s90, v16, s4
    v_readlane_b32 s91, v16, s5
    v_readlane_b32 s89, v16, 16
    v_readlane_b32 s84, v18, s4
    v_readlane_b32 s85, v18, s5
    v_readlane_b32 s50, v24, s48
    v_readlane_b32 s51, v24, s49
    v_readlane_b32 s54, v24, s4
    v_readlane_b32 s55, v24, s5
    s_and_b32 s6, vcc_lo, 0xffff
    s_cbranch_scc0 K_FITS
    s_cmp_le_u32 s87, 12
    s_cbranch_scc1 K_FITS
    s_barrier
    s_lshr_b32 s87, s87, 1
    v_mov_b32 v16, 0x40000000
    v_cmp_gt_u32 vcc, s87, v3
    s_nop 1
    v_cndmask_b32 v3, v16, v3, vcc
    s_waitcnt vmcnt(0)
    s_branch K_RESET
K_FITS:
    s_lshl_b32 s4, s84, 7
    s_add_u32 s79, s4, s78
    s_lshl_b32 s5, s85, 7
    s_add_u32 s81, s5, s80
    s_sub_u32 s4, s79, s90
    s_lshr_b32 s4, s4, 5
    s_lshl_b32 s4, s4, 2
    s_sub_u32 s56, 16, s4
    s_max_u32 s56, s56, 4
    s_sub_u32 s4, s81, s91
    s_lshr_b32 s4, s4, 5
    s_lshl_b32 s4, s4, 2
    s_sub_u32 s53, 16, s4
    s_max_u32 s53, s53, 4
    s_cmp_lt_u32 s56, 16
    s_cselect_b32 s52, 1, -1
    v_add_u32 v16, s90, v223
    v_cmp_gt_u32 vcc, s79, v16
    s_nop 0
    s_and_b64 exec, vcc, s[70:71]
    ds_write_b32 v16, v19
    ds_write2st64_b32 v16, v250, v250 offset0:74 offset1:148
    s_mov_b64 exec, -1
    v_add_u32 v16, s91, v223
    v_cmp_gt_u32 vcc, s81, v16
    s_nop 0
    s_and_b64 exec, vcc, s[72:73]
    ds_write_b32 v16, v19
    ds_write2st64_b32 v16, v250, v250 offset0:74 offset1:148
    s_mov_b64 exec, -1
    v_mov_b32 v2, v0
    s_add_u32 s50, s50, s51
    s_add_u32 s51, s54, s55
    s_mul_i32 s50, s50, 125
    s_mul_i32 s51, s51, 51
    s_sub_i32 s50, s50, s51
    s_add_i32 s50, s50, 128
    s_ashr_i32 s50, s50, 9
    s_max_i32 s50, s50, 0
    s_lshr_b32 s51, s50, 1
    s_sub_i32 s95, s84, s51
    s_sub_i32 s95, s95, 1
    s_max_i32 s95, s95, 0
    s_cmp_lt_u32 s64, 4
    s_cselect_b32 s95, -1, s95
    s_mov_b32 s101, s95
    s_bitcmp1_b32 s50, 0
    s_cselect_b32 s95, -1, s95
    s_cmp_eq_u32 s57, 0
    s_cbranch_scc1 K_LATEG
    s_add_u32 s78, s78, 128
    s_add_u32 s78, s78, 128
    s_cmp_eq_u32 s78, s79
    s_cselect_b32 s78, s80, s78
    s_cselect_b32 s79, s81, s79
    s_cselect_b32 s80, s82, s80
    s_cselect_b32 s81, s83, s81
    s_branch K_GDONE
K_LATEG:
    v_add_u32 v249, s78, v222
    v_add_u32 v230, s78, v223
    ds_read_b128 v[20:23], v249
    ds_read_b32 v228, v230
    s_add_u32 s78, s78, 128
    s_cmp_eq_u32 s78, s79
    s_cselect_b32 s78, s80, s78
    s_cselect_b32 s79, s81, s79
    s_cselect_b32 s80, s82, s80
    s_cselect_b32 s81, s83, s81
    v_add_u32 v249, s78, v222
    v_add_u32 v231, s78, v223
    ds_read_b128 v[224:227], v249
    ds_read_b32 v229, v231
    s_add_u32 s78, s78, 128
    s_cmp_eq_u32 s78, s79
    s_cselect_b32 s78, s80, s78
    s_cselect_b32 s79, s81, s79
    s_cselect_b32 s80, s82, s80
    s_cselect_b32 s81, s83, s81
    s_waitcnt lgkmcnt(2)
    v_and_or_b32 v20, v20, s74, v212
    v_and_or_b32 v21, v21, s74, v213
    v_and_or_b32 v22, v22, s74, v214
    v_and_or_b32 v23, v23, s74, v215
    s_add_u32 m0, s86, 0
    s_nop 0
    buffer_load_dwordx4 v20, s[32:35], 0 offen offset:0  lds
    buffer_load_dwordx4 v21, s[36:39], 0 offen offset:1024  lds
    buffer_load_dwordx4 v22, s[40:43], 0 offen offset:2048  lds
    buffer_load_dwordx4 v23, s[44:47], 0 offen offset:3072  lds
    v_bfe_u32 v253, v228, 7, 15
    v_mul_u32_u24 v253, 6, v253
    v_mov_b32 v232, 0
    v_mov_b32 v233, 0
    v_mov_b32 v234, 0
    s_mov_b64 exec, s[72:73]
    buffer_load_short_d16_hi v232, v253, s[20:23], 0 offen offset:0
    buffer_load_short_d16_hi v233, v253, s[20:23], 0 offen offset:2
    buffer_load_short_d16_hi v234, v253, s[20:23], 0 offen offset:4
    s_mov_b64 exec, -1
    s_waitcnt lgkmcnt(0)
    v_and_or_b32 v224, v224, s74, v212
    v_and_or_b32 v225, v225, s74, v213
    v_and_or_b32 v226, v226, s74, v214
    v_and_or_b32 v227, v227, s74, v215
    s_add_u32 m0, s86, 4096
    s_nop 0
    buffer_load_dwordx4 v224, s[32:35], 0 offen offset:0  lds
    buffer_load_dwordx4 v225, s[36:39], 0 offen offset:1024  lds
    buffer_load_dwordx4 v226, s[40:43], 0 offen offset:2048  lds
    buffer_load_dwordx4 v227, s[44:47], 0 offen offset:3072  lds
K_GDONE:
    s_cmp_eq_u32 s88, 1
    s_cbranch_scc1 K_FILL2
    v_lshlrev_b32 v16, 4, v1
    s_mov_b32 s3, s94
    buffer_load_dwordx4 v[148:151], v16, s[28:31], s3 offen offset:0 sc0 sc1
    buffer_load_dwordx4 v[152:155], v16, s[28:31], s3 offen offset:1024 sc0 sc1
    buffer_load_dwordx4 v[156:159], v16, s[28:31], s3 offen offset:2048 sc0 sc1
    buffer_load_dwordx4 v[160:163], v16, s[28:31], s3 offen offset:3072 sc0 sc1
    s_add_u32 s3, s3, 4096
    buffer_load_dwordx4 v[164:167], v16, s[28:31], s3 offen offset:0 sc0 sc1
    buffer_load_dwordx4 v[168:171], v16, s[28:31], s3 offen offset:1024 sc0 sc1
    buffer_load_dwordx4 v[172:175], v16, s[28:31], s3 offen offset:2048 sc0 sc1
    buffer_load_dwordx4 v[176:179], v16, s[28:31], s3 offen offset:3072 sc0 sc1
    s_add_u32 s3, s3, 4096
    buffer_load_dwordx4 v[180:183], v16, s[28:31], s3 offen offset:0 sc0 sc1
    buffer_load_dwordx4 v[184:187], v16, s[28:31], s3 offen offset:1024 sc0 sc1
    buffer_load_dwordx4 v[188:191], v16, s[28:31], s3 offen offset:2048 sc0 sc1
    buffer_load_dwordx4 v[192:195], v16, s[28:31], s3 offen offset:3072 sc0 sc1
    s_add_u32 s3, s3, 4096
    buffer_load_dwordx4 v[196:199], v16, s[28:31], s3 offen offset:0 sc0 sc1
    buffer_load_dwordx4 v[200:203], v16, s[28:31], s3 offen offset:1024 sc0 sc1
    buffer_load_dwordx4 v[204:207], v16, s[28:31], s3 offen offset:2048 sc0 sc1
    buffer_load_dwordx4 v[208:211], v16, s[28:31], s3 offen offset:3072 sc0 sc1
    s_add_u32 s3, s3, 4096
    s_waitcnt vmcnt(0)
K_FILL2:
    v_and_b32 v247, 0x38, v228
    v_lshl_add_u32 v248, v247, 1, s75
    ds_read_b96 v[240:242], v248 offset:128
    v_bfe_u32 v253, v229, 7, 15
    s_waitcnt vmcnt(4) lgkmcnt(0)
    ds_read_b128 v[80:83], v216 offset:0
    ds_read_b128 v[84:87], v217 offset:0
    ds_read_b128 v[88:91], v218 offset:0
    ds_read_b128 v[92:95], v219 offset:0
    s_mov_b64 exec, s[70:71]
    ds_read_b128 v[96:99], v248
    s_mov_b64 exec, s[72:73]
    v_sub_f32 v240, v240, v232
    v_sub_f32 v241, v241, v233
    v_sub_f32 v242, v242, v234
    v_cvt_pk_bf16_f32 v244, 1.0, v240
    v_cvt_pk_bf16_f32 v245, v241, v242
    v_dot2_f32_bf16 v252, v244, v244, -1.0
    v_dot2_f32_bf16 v252, v245, v245, v252
    ds_read2st64_b32 v[96:97], v230 offset0:74 offset1:148
    v_add_u32 v246, v247, v221
    ds_write_b64 v246, v[244:245]
    buffer_load_dwordx3 v[232:234], v253, s[12:15], 0 idxen sc1
    v_cvt_pk_bf16_f32 v98, v252, v252
    s_mov_b64 exec, -1
    v_add_u32 v249, s78, v222
    v_add_u32 v230, s78, v223
    ds_read_b128 v[224:227], v249
    ds_read_b32 v228, v230
    s_add_u32 s78, s78, 128
    s_cmp_eq_u32 s78, s79
    s_cselect_b32 s78, s80, s78
    s_cselect_b32 s79, s81, s79
    s_cselect_b32 s80, s82, s80
    s_cselect_b32 s81, s83, s81
    s_waitcnt lgkmcnt(5)
    v_mfma_f32_32x32x16_bf16 v[16:31], v[80:83], v[100:103], 0
    v_mfma_f32_32x32x16_bf16 v[16:31], v[84:87], v[104:107], v[16:31]
    v_mfma_f32_32x32x16_bf16 v[16:31], v[88:91], v[108:111], v[16:31]
    v_mfma_f32_32x32x16_bf16 v[16:31], v[92:95], v[112:115], v[16:31]
    s_waitcnt lgkmcnt(0)
    v_mfma_f32_32x32x16_bf16 v[16:31], v[96:99], v[132:135], v[16:31]
    v_and_or_b32 v224, v224, s74, v212
    v_and_or_b32 v225, v225, s74, v213
    v_and_or_b32 v226, v226, s74, v214
    v_and_or_b32 v227, v227, s74, v215
    s_add_u32 m0, s86, 0
    s_nop 0
    buffer_load_dwordx4 v224, s[32:35], 0 offen offset:0  lds
    buffer_load_dwordx4 v225, s[36:39], 0 offen offset:1024  lds
    buffer_load_dwordx4 v226, s[40:43], 0 offen offset:2048  lds
    buffer_load_dwordx4 v227, s[44:47], 0 offen offset:3072  lds
    s_nop 3
K_XA0:
    s_cmp_eq_u32 s84, s52
    s_cbranch_scc1 K_XAH0
    s_sub_u32 s84, s84, 1
    s_cmp_eq_u32 s84, 0
    s_cselect_b32 s75, s77, s76
    v_exp_f32 v48, v16
    v_mfma_f32_32x32x16_bf16 v[164:179], v[72:75], v[64:67], v[164:179]
    v_and_b32 v247, 0x38, v229
    v_lshl_add_u32 v248, v247, 1, s75
    ds_read_b96 v[240:242], v248 offset:128
    v_bfe_u32 v253, v228, 7, 15
    v_exp_f32 v49, v17
    v_exp_f32 v50, v18
    s_cmp_lg_u32 s84, s95
    s_cbranch_scc1 KP1
    s_setprio 1
KP1:
    v_exp_f32 v51, v19
    v_mfma_f32_32x32x16_bf16 v[164:179], v[76:79], v[68:71], v[164:179]
    v_exp_f32 v52, v20
    ds_read_b64_tr_b16 v[72:73], v220 offset:0
    ds_read_b64_tr_b16 v[74:75], v220 offset:512
    v_exp_f32 v53, v21
    ds_read_b64_tr_b16 v[76:77], v220 offset:1024
    ds_read_b64_tr_b16 v[78:79], v220 offset:1536
    v_exp_f32 v54, v22
    v_exp_f32 v55, v23
    v_exp_f32 v56, v24
    v_exp_f32 v57, v25
    v_exp_f32 v58, v26
    v_exp_f32 v59, v27
    v_exp_f32 v60, v28
    v_exp_f32 v61, v29
    v_exp_f32 v62, v30
    v_exp_f32 v63, v31
    v_pk_add_f32 v[48:49], v[48:49], 1.0 op_sel_hi:[1,0]
    v_pk_add_f32 v[50:51], v[50:51], 1.0 op_sel_hi:[1,0]
    v_pk_add_f32 v[52:53], v[52:53], 1.0 op_sel_hi:[1,0]
    v_pk_add_f32 v[54:55], v[54:55], 1.0 op_sel_hi:[1,0]
    v_pk_add_f32 v[56:57], v[56:57], 1.0 op_sel_hi:[1,0]
    v_pk_add_f32 v[58:59], v[58:59], 1.0 op_sel_hi:[1,0]
    v_pk_add_f32 v[60:61], v[60:61], 1.0 op_sel_hi:[1,0]
    v_pk_add_f32 v[62:63], v[62:63], 1.0 op_sel_hi:[1,0]
    v_rcp_f32 v48, v48
    v_mfma_f32_32x32x16_bf16 v[32:47], v[96:99], v[136:139], 0
    v_rcp_f32 v49, v49
    s_waitcnt vmcnt(4) lgkmcnt(4)
    s_mov_b64 exec, s[70:71]
    ds_read_b128 v[96:99], v248
    s_mov_b64 exec, s[72:73]
    v_sub_f32 v240, v240, v232
    v_sub_f32 v241, v241, v233
    v_sub_f32 v242, v242, v234
    v_cvt_pk_bf16_f32 v244, 1.0, v240
    v_cvt_pk_bf16_f32 v245, v241, v242
    v_dot2_f32_bf16 v252, v244, v244, -1.0
    v_dot2_f32_bf16 v252, v245, v245, v252
    ds_read2st64_b32 v[96:97], v231 offset0:74 offset1:148
    ds_write_b64 v246, v[250:251]
    v_add_u32 v246, v247, v221
    ds_write_b64 v246, v[244:245]
    buffer_load_dwordx3 v[232:234], v253, s[12:15], 0 idxen sc1
    v_cvt_pk_bf16_f32 v98, v252, v252
    s_mov_b64 exec, -1
    v_rcp_f32 v50, v50
    v_add_u32 v249, s78, v222
    v_add_u32 v231, s78, v223
    ds_read_b128 v[224:227], v249
    ds_read_b32 v229, v231
    s_add_u32 s78, s78, 128
    s_cmp_eq_u32 s78, s79
    s_cselect_b32 s78, s80, s78
    s_cselect_b32 s79, s81, s79
    s_cselect_b32 s80, s82, s80
    s_cselect_b32 s81, s83, s81
    v_rcp_f32 v51, v51
    v_mfma_f32_32x32x16_bf16 v[32:47], v[80:83], v[116:119], v[32:47]
    v_rcp_f32 v52, v52
    v_rcp_f32 v53, v53
    v_rcp_f32 v54, v54
    v_mfma_f32_32x32x16_bf16 v[32:47], v[84:87], v[120:123], v[32:47]
    v_rcp_f32 v55, v55
    v_rcp_f32 v56, v56
    v_rcp_f32 v57, v57
    v_mfma_f32_32x32x16_bf16 v[32:47], v[88:91], v[124:127], v[32:47]
    v_rcp_f32 v58, v58
    v_rcp_f32 v59, v59
    v_rcp_f32 v60, v60
    v_mfma_f32_32x32x16_bf16 v[32:47], v[92:95], v[128:131], v[32:47]
    v_rcp_f32 v61, v61
    ds_read_b128 v[80:83], v216 offset:4096
    ds_read_b128 v[84:87], v217 offset:4096
    ds_read_b128 v[88:91], v218 offset:4096
    ds_read_b128 v[92:95], v219 offset:4096
    v_rcp_f32 v62, v62
    v_rcp_f32 v63, v63
    v_pk_mul_f32 v[48:49], v[48:49], v[16:17]
    v_pk_mul_f32 v[50:51], v[50:51], v[18:19]
    v_pk_mul_f32 v[52:53], v[52:53], v[20:21]
    v_pk_mul_f32 v[54:55], v[54:55], v[22:23]
    v_pk_mul_f32 v[56:57], v[56:57], v[24:25]
    v_pk_mul_f32 v[58:59], v[58:59], v[26:27]
    v_pk_mul_f32 v[60:61], v[60:61], v[28:29]
    v_pk_mul_f32 v[62:63], v[62:63], v[30:31]
    v_cvt_pk_bf16_f32 v64, v48, v49
    v_cvt_pk_bf16_f32 v65, v50, v51
    v_cvt_pk_bf16_f32 v66, v52, v53
    v_cvt_pk_bf16_f32 v67, v54, v55
    v_cvt_pk_bf16_f32 v68, v56, v57
    v_cvt_pk_bf16_f32 v69, v58, v59
    v_cvt_pk_bf16_f32 v70, v60, v61
    s_cmp_lg_u32 s84, s101
    s_cbranch_scc1 KP2
    s_setprio 1
KP2:
    v_cvt_pk_bf16_f32 v71, v62, v63
    s_cmp_eq_u32 s84, 0
    s_cbranch_scc1 K_YT0
    s_waitcnt lgkmcnt(10)
    v_exp_f32 v48, v32
    v_mfma_f32_32x32x16_bf16 v[148:163], v[72:75], v[64:67], v[148:163]
    s_add_u32 m0, s86, 4096
    v_exp_f32 v49, v33
    s_waitcnt lgkmcnt(5)
    v_and_or_b32 v224, v224, s74, v212
    v_and_or_b32 v225, v225, s74, v213
    v_and_or_b32 v226, v226, s74, v214
    v_and_or_b32 v227, v227, s74, v215
    v_exp_f32 v50, v34
    v_exp_f32 v51, v35
    v_mfma_f32_32x32x16_bf16 v[148:163], v[76:79], v[68:71], v[148:163]
    v_exp_f32 v52, v36
    v_exp_f32 v53, v37
    v_exp_f32 v54, v38
    s_waitcnt lgkmcnt(0)
    v_mfma_f32_32x32x16_bf16 v[16:31], v[80:83], v[100:103], 0
    v_exp_f32 v55, v39
    buffer_load_dwordx4 v224, s[32:35], 0 offen offset:0  lds
    v_exp_f32 v56, v40
    buffer_load_dwordx4 v225, s[36:39], 0 offen offset:1024  lds
    v_exp_f32 v57, v41
    v_exp_f32 v58, v42
    buffer_load_dwordx4 v226, s[40:43], 0 offen offset:2048  lds
    v_exp_f32 v59, v43
    buffer_load_dwordx4 v227, s[44:47], 0 offen offset:3072  lds
    v_exp_f32 v60, v44
    v_exp_f32 v61, v45
    v_exp_f32 v62, v46
    v_exp_f32 v63, v47
    v_pk_add_f32 v[48:49], v[48:49], 1.0 op_sel_hi:[1,0]
    v_pk_add_f32 v[50:51], v[50:51], 1.0 op_sel_hi:[1,0]
    v_pk_add_f32 v[52:53], v[52:53], 1.0 op_sel_hi:[1,0]
    v_pk_add_f32 v[54:55], v[54:55], 1.0 op_sel_hi:[1,0]
    v_pk_add_f32 v[56:57], v[56:57], 1.0 op_sel_hi:[1,0]
    v_pk_add_f32 v[58:59], v[58:59], 1.0 op_sel_hi:[1,0]
    v_pk_add_f32 v[60:61], v[60:61], 1.0 op_sel_hi:[1,0]
    v_pk_add_f32 v[62:63], v[62:63], 1.0 op_sel_hi:[1,0]
    v_rcp_f32 v48, v48
    v_mfma_f32_32x32x16_bf16 v[16:31], v[84:87], v[104:107], v[16:31]
    v_rcp_f32 v49, v49
    v_rcp_f32 v50, v50
    v_rcp_f32 v51, v51
    v_mfma_f32_32x32x16_bf16 v[16:31], v[88:91], v[108:111], v[16:31]
    v_rcp_f32 v52, v52
    v_rcp_f32 v53, v53
    v_rcp_f32 v54, v54
    v_mfma_f32_32x32x16_bf16 v[16:31], v[92:95], v[112:115], v[16:31]
    v_rcp_f32 v55, v55
    v_rcp_f32 v56, v56
    v_rcp_f32 v57, v57
    v_mfma_f32_32x32x16_bf16 v[16:31], v[96:99], v[132:135], v[16:31]
    v_rcp_f32 v58, v58
    v_rcp_f32 v59, v59
    v_rcp_f32 v60, v60
    v_rcp_f32 v61, v61
    v_rcp_f32 v62, v62
    v_rcp_f32 v63, v63
    v_pk_mul_f32 v[48:49], v[48:49], v[32:33]
    v_pk_mul_f32 v[50:51], v[50:51], v[34:35]
    v_pk_mul_f32 v[52:53], v[52:53], v[36:37]
    v_pk_mul_f32 v[54:55], v[54:55], v[38:39]
    v_pk_mul_f32 v[56:57], v[56:57], v[40:41]
    v_pk_mul_f32 v[58:59], v[58:59], v[42:43]
    v_pk_mul_f32 v[60:61], v[60:61], v[44:45]
    v_pk_mul_f32 v[62:63], v[62:63], v[46:47]
    v_cvt_pk_bf16_f32 v64, v48, v49
    v_cvt_pk_bf16_f32 v65, v50, v51
    v_cvt_pk_bf16_f32 v66, v52, v53
    v_cvt_pk_bf16_f32 v67, v54, v55
    v_cvt_pk_bf16_f32 v68, v56, v57
    v_cvt_pk_bf16_f32 v69, v58, v59
    v_cvt_pk_bf16_f32 v70, v60, v61
    v_cvt_pk_bf16_f32 v71, v62, v63
    s_cmp_eq_u32 s84, s52
    s_cbranch_scc1 K_XAH1
    s_sub_u32 s84, s84, 1
    s_cmp_eq_u32 s84, 0
    s_cselect_b32 s75, s77, s76
    v_exp_f32 v48, v16
    v_mfma_f32_32x32x16_bf16 v[164:179], v[72:75], v[64:67], v[164:179]
    v_and_b32 v247, 0x38, v228
    v_lshl_add_u32 v248, v247, 1, s75
    ds_read_b96 v[240:242], v248 offset:128
    v_bfe_u32 v253, v229, 7, 15
    v_exp_f32 v49, v17
    v_exp_f32 v50, v18
    s_cmp_lg_u32 s84, s95
    s_cbranch_scc1 KP3
    s_setprio 1
KP3:
    v_exp_f32 v51, v19
    v_mfma_f32_32x32x16_bf16 v[164:179], v[76:79], v[68:71], v[164:179]
    v_exp_f32 v52, v20
    ds_read_b64_tr_b16 v[72:73], v220 offset:0
    ds_read_b64_tr_b16 v[74:75], v220 offset:512
    v_exp_f32 v53, v21
    ds_read_b64_tr_b16 v[76:77], v220 offset:1024
    ds_read_b64_tr_b16 v[78:79], v220 offset:1536
    v_exp_f32 v54, v22
    v_exp_f32 v55, v23
    v_exp_f32 v56, v24
    v_exp_f32 v57, v25
    v_exp_f32 v58, v26
    v_exp_f32 v59, v27
    v_exp_f32 v60, v28
    v_exp_f32 v61, v29
    v_exp_f32 v62, v30
    v_exp_f32 v63, v31
    v_pk_add_f32 v[48:49], v[48:49], 1.0 op_sel_hi:[1,0]
    v_pk_add_f32 v[50:51], v[50:51], 1.0 op_sel_hi:[1,0]
    v_pk_add_f32 v[52:53], v[52:53], 1.0 op_sel_hi:[1,0]
    v_pk_add_f32 v[54:55], v[54:55], 1.0 op_sel_hi:[1,0]
    v_pk_add_f32 v[56:57], v[56:57], 1.0 op_sel_hi:[1,0]
    v_pk_add_f32 v[58:59], v[58:59], 1.0 op_sel_hi:[1,0]
    v_pk_add_f32 v[60:61], v[60:61], 1.0 op_sel_hi:[1,0]
    v_pk_add_f32 v[62:63], v[62:63], 1.0 op_sel_hi:[1,0]
    v_rcp_f32 v48, v48
    v_mfma_f32_32x32x16_bf16 v[32:47], v[96:99], v[136:139], 0
    v_rcp_f32 v49, v49
    s_waitcnt vmcnt(4) lgkmcnt(4)
    s_mov_b64 exec, s[70:71]
    ds_read_b128 v[96:99], v248
    s_mov_b64 exec, s[72:73]
    v_sub_f32 v240, v240, v232
    v_sub_f32 v241, v241, v233
    v_sub_f32 v242, v242, v234
    v_cvt_pk_bf16_f32 v244, 1.0, v240
    v_cvt_pk_bf16_f32 v245, v241, v242
    v_dot2_f32_bf16 v252, v244, v244, -1.0
    v_dot2_f32_bf16 v252, v245, v245, v252
    ds_read2st64_b32 v[96:97], v230 offset0:74 offset1:148
    ds_write_b64 v246, v[250:251]
    v_add_u32 v246, v247, v221
    ds_write_b64 v246, v[244:245]
    buffer_load_dwordx3 v[232:234], v253, s[12:15], 0 idxen sc1
    v_cvt_pk_bf16_f32 v98, v252, v252
    s_mov_b64 exec, -1
    v_rcp_f32 v50, v50
    v_add_u32 v249, s78, v222
    v_add_u32 v230, s78, v223
    ds_read_b128 v[224:227], v249
    ds_read_b32 v228, v230
    s_add_u32 s78, s78, 128
    s_cmp_eq_u32 s78, s79
    s_cselect_b32 s78, s80, s78
    s_cselect_b32 s79, s81, s79
    s_cselect_b32 s80, s82, s80
    s_cselect_b32 s81, s83, s81
    v_rcp_f32 v51, v51
    v_mfma_f32_32x32x16_bf16 v[32:47], v[80:83], v[116:119], v[32:47]
    v_rcp_f32 v52, v52
    v_rcp_f32 v53, v53
    v_rcp_f32 v54, v54
    v_mfma_f32_32x32x16_bf16 v[32:47], v[84:87], v[120:123], v[32:47]
    v_rcp_f32 v55, v55
    v_rcp_f32 v56, v56
    v_rcp_f32 v57, v57
    v_mfma_f32_32x32x16_bf16 v[32:47], v[88:91], v[124:127], v[32:47]
    v_rcp_f32 v58, v58
    v_rcp_f32 v59, v59
    v_rcp_f32 v60, v60
    v_mfma_f32_32x32x16_bf16 v[32:47], v[92:95], v[128:131], v[32:47]
    v_rcp_f32 v61, v61
    ds_read_b128 v[80:83], v216 offset:0
    ds_read_b128 v[84:87], v217 offset:0
    ds_read_b128 v[88:91], v218 offset:0
    ds_read_b128 v[92:95], v219 offset:0
    v_rcp_f32 v62, v62
    v_rcp_f32 v63, v63
    v_pk_mul_f32 v[48:49], v[48:49], v[16:17]
    v_pk_mul_f32 v[50:51], v[50:51], v[18:19]
    v_pk_mul_f32 v[52:53], v[52:53], v[20:21]
    v_pk_mul_f32 v[54:55], v[54:55], v[22:23]
    v_pk_mul_f32 v[56:57], v[56:57], v[24:25]
    v_pk_mul_f32 v[58:59], v[58:59], v[26:27]
    v_pk_mul_f32 v[60:61], v[60:61], v[28:29]
    v_pk_mul_f32 v[62:63], v[62:63], v[30:31]
    v_cvt_pk_bf16_f32 v64, v48, v49
    v_cvt_pk_bf16_f32 v65, v50, v51
    v_cvt_pk_bf16_f32 v66, v52, v53
    v_cvt_pk_bf16_f32 v67, v54, v55
    v_cvt_pk_bf16_f32 v68, v56, v57
    v_cvt_pk_bf16_f32 v69, v58, v59
    v_cvt_pk_bf16_f32 v70, v60, v61
    s_cmp_lg_u32 s84, s101
    s_cbranch_scc1 KP4
    s_setprio 1
KP4:
    v_cvt_pk_bf16_f32 v71, v62, v63
    s_cmp_eq_u32 s84, 0
    s_cbranch_scc1 K_YT1
    s_waitcnt lgkmcnt(10)
    v_exp_f32 v48, v32
    v_mfma_f32_32x32x16_bf16 v[148:163], v[72:75], v[64:67], v[148:163]
    s_add_u32 m0, s86, 0
    v_exp_f32 v49, v33
    s_waitcnt lgkmcnt(5)
    v_and_or_b32 v224, v224, s74, v212
    v_and_or_b32 v225, v225, s74, v213
    v_and_or_b32 v226, v226, s74, v214
    v_and_or_b32 v227, v227, s74, v215
    v_exp_f32 v50, v34
    v_exp_f32 v51, v35
    v_mfma_f32_32x32x16_bf16 v[148:163], v[76:79], v[68:71], v[148:163]
    v_exp_f32 v52, v36
    v_exp_f32 v53, v37
    v_exp_f32 v54, v38
    s_waitcnt lgkmcnt(0)
    v_mfma_f32_32x32x16_bf16 v[16:31], v[80:83], v[100:103], 0
    v_exp_f32 v55, v39
    buffer_load_dwordx4 v224, s[32:35], 0 offen offset:0  lds
    v_exp_f32 v56, v40
    buffer_load_dwordx4 v225, s[36:39], 0 offen offset:1024  lds
    v_exp_f32 v57, v41
    v_exp_f32 v58, v42
    buffer_load_dwordx4 v226, s[40:43], 0 offen offset:2048  lds
    v_exp_f32 v59, v43
    buffer_load_dwordx4 v227, s[44:47], 0 offen offset:3072  lds
    v_exp_f32 v60, v44
    v_exp_f32 v61, v45
    v_exp_f32 v62, v46
    v_exp_f32 v63, v47
    v_pk_add_f32 v[48:49], v[48:49], 1.0 op_sel_hi:[1,0]
    v_pk_add_f32 v[50:51], v[50:51], 1.0 op_sel_hi:[1,0]
    v_pk_add_f32 v[52:53], v[52:53], 1.0 op_sel_hi:[1,0]
    v_pk_add_f32 v[54:55], v[54:55], 1.0 op_sel_hi:[1,0]
    v_pk_add_f32 v[56:57], v[56:57], 1.0 op_sel_hi:[1,0]
    v_pk_add_f32 v[58:59], v[58:59], 1.0 op_sel_hi:[1,0]
    v_pk_add_f32 v[60:61], v[60:61], 1.0 op_sel_hi:[1,0]
    v_pk_add_f32 v[62:63], v[62:63], 1.0 op_sel_hi:[1,0]
    v_rcp_f32 v48, v48
    v_mfma_f32_32x32x16_bf16 v[16:31], v[84:87], v[104:107], v[16:31]
    v_rcp_f32 v49, v49
    v_rcp_f32 v50, v50
    v_rcp_f32 v51, v51
    v_mfma_f32_32x32x16_bf16 v[16:31], v[88:91], v[108:111], v[16:31]
    v_rcp_f32 v52, v52
    v_rcp_f32 v53, v53
    v_rcp_f32 v54, v54
    v_mfma_f32_32x32x16_bf16 v[16:31], v[92:95], v[112:115], v[16:31]
    v_rcp_f32 v55, v55
    v_rcp_f32 v56, v56
    v_rcp_f32 v57, v57
    v_mfma_f32_32x32x16_bf16 v[16:31], v[96:99], v[132:135], v[16:31]
    v_rcp_f32 v58, v58
    v_rcp_f32 v59, v59
    v_rcp_f32 v60, v60
    v_rcp_f32 v61, v61
    v_rcp_f32 v62, v62
    v_rcp_f32 v63, v63
    v_pk_mul_f32 v[48:49], v[48:49], v[32:33]
    v_pk_mul_f32 v[50:51], v[50:51], v[34:35]
    v_pk_mul_f32 v[52:53], v[52:53], v[36:37]
    v_pk_mul_f32 v[54:55], v[54:55], v[38:39]
    v_pk_mul_f32 v[56:57], v[56:57], v[40:41]
    v_pk_mul_f32 v[58:59], v[58:59], v[42:43]
    v_pk_mul_f32 v[60:61], v[60:61], v[44:45]
    v_pk_mul_f32 v[62:63], v[62:63], v[46:47]
    v_cvt_pk_bf16_f32 v64, v48, v49
    v_cvt_pk_bf16_f32 v65, v50, v51
    v_cvt_pk_bf16_f32 v66, v52, v53
    v_cvt_pk_bf16_f32 v67, v54, v55
    v_cvt_pk_bf16_f32 v68, v56, v57
    v_cvt_pk_bf16_f32 v69, v58, v59
    v_cvt_pk_bf16_f32 v70, v60, v61
    v_cvt_pk_bf16_f32 v71, v62, v63
    s_branch K_XA0
K_XAH0:
    s_cmp_eq_u32 s56, 12
    s_cbranch_scc1 K_XAH0_12
    s_cmp_eq_u32 s56, 8
    s_cbranch_scc1 K_XAH0_8
K_XAH0_4:
    s_sub_u32 s84, s84, 1
    s_cmp_eq_u32 s84, 0
    s_cselect_b32 s75, s77, s76
    v_exp_f32 v48, v16
    v_mfma_f32_32x32x16_bf16 v[164:179], v[72:75], v[64:67], v[164:179]
    v_and_b32 v247, 0x38, v229
    v_lshl_add_u32 v248, v247, 1, s75
    ds_read_b96 v[240:242], v248 offset:128
    v_bfe_u32 v253, v228, 7, 15
    v_exp_f32 v49, v17
    v_exp_f32 v50, v18
    s_cmp_lg_u32 s84, s95
    s_cbranch_scc1 KP5
    s_setprio 1
KP5:
    v_exp_f32 v51, v19
    v_mfma_f32_32x32x16_bf16 v[164:179], v[76:79], v[68:71], v[164:179]
    v_pk_add_f32 v[48:49], v[48:49], 1.0 op_sel_hi:[1,0]
    ds_read_b64_tr_b16 v[72:73], v220 offset:0
    ds_read_b64_tr_b16 v[74:75], v220 offset:512
    v_pk_add_f32 v[50:51], v[50:51], 1.0 op_sel_hi:[1,0]
    ds_read_b64_tr_b16 v[76:77], v220 offset:1024
    ds_read_b64_tr_b16 v[78:79], v220 offset:1536
    v_rcp_f32 v48, v48
    v_mfma_f32_32x32x16_bf16 v[32:47], v[96:99], v[136:139], 0
    v_rcp_f32 v49, v49
    s_waitcnt vmcnt(4) lgkmcnt(4)
    s_mov_b64 exec, s[70:71]
    ds_read_b128 v[96:99], v248
    s_mov_b64 exec, s[72:73]
    v_sub_f32 v240, v240, v232
    v_sub_f32 v241, v241, v233
    v_sub_f32 v242, v242, v234
    v_cvt_pk_bf16_f32 v244, 1.0, v240
    v_cvt_pk_bf16_f32 v245, v241, v242
    v_dot2_f32_bf16 v252, v244, v244, -1.0
    v_dot2_f32_bf16 v252, v245, v245, v252
    ds_read2st64_b32 v[96:97], v231 offset0:74 offset1:148
    ds_write_b64 v246, v[250:251]
    v_add_u32 v246, v247, v221
    ds_write_b64 v246, v[244:245]
    buffer_load_dwordx3 v[232:234], v253, s[12:15], 0 idxen sc1
    v_cvt_pk_bf16_f32 v98, v252, v252
    s_mov_b64 exec, -1
    v_rcp_f32 v50, v50
    v_add_u32 v249, s78, v222
    v_add_u32 v231, s78, v223
    ds_read_b128 v[224:227], v249
    ds_read_b32 v229, v231
    s_add_u32 s78, s78, 128
    s_cmp_eq_u32 s78, s79
    s_cselect_b32 s78, s80, s78
    s_cselect_b32 s79, s81, s79
    s_cselect_b32 s80, s82, s80
    s_cselect_b32 s81, s83, s81
    v_rcp_f32 v51, v51
    v_mfma_f32_32x32x16_bf16 v[32:47], v[80:83], v[116:119], v[32:47]
    v_pk_mul_f32 v[48:49], v[48:49], v[16:17]
    v_pk_mul_f32 v[50:51], v[50:51], v[18:19]
    v_cvt_pk_bf16_f32 v64, v48, v49
    s_cmp_lg_u32 s84, s101
    s_cbranch_scc1 KP6
    s_setprio 1
KP6:
    v_mfma_f32_32x32x16_bf16 v[32:47], v[84:87], v[120:123], v[32:47]
    v_cvt_pk_bf16_f32 v65, v50, v51
    v_mfma_f32_32x32x16_bf16 v[32:47], v[88:91], v[124:127], v[32:47]
    v_mfma_f32_32x32x16_bf16 v[32:47], v[92:95], v[128:131], v[32:47]
    ds_read_b128 v[80:83], v216 offset:4096
    ds_read_b128 v[84:87], v217 offset:4096
    ds_read_b128 v[88:91], v218 offset:4096
    ds_read_b128 v[92:95], v219 offset:4096
    s_waitcnt lgkmcnt(10)
    s_nop 6
    v_exp_f32 v48, v32
    v_mfma_f32_32x32x16_bf16 v[148:163], v[72:75], v[64:67], v[148:163]
    s_add_u32 m0, s86, 4096
    v_exp_f32 v49, v33
    s_waitcnt lgkmcnt(5)
    v_and_or_b32 v224, v224, s74, v212
    v_and_or_b32 v225, v225, s74, v213
    v_and_or_b32 v226, v226, s74, v214
    v_and_or_b32 v227, v227, s74, v215
    v_exp_f32 v50, v34
    s_waitcnt lgkmcnt(0)
    v_mfma_f32_32x32x16_bf16 v[16:31], v[80:83], v[100:103], 0
    v_exp_f32 v51, v35
    buffer_load_dwordx4 v224, s[32:35], 0 offen offset:0  lds
    v_pk_add_f32 v[48:49], v[48:49], 1.0 op_sel_hi:[1,0]
    v_pk_add_f32 v[50:51], v[50:51], 1.0 op_sel_hi:[1,0]
    v_rcp_f32 v48, v48
    v_mfma_f32_32x32x16_bf16 v[16:31], v[84:87], v[104:107], v[16:31]
    buffer_load_dwordx4 v225, s[36:39], 0 offen offset:1024  lds
    v_rcp_f32 v49, v49
    buffer_load_dwordx4 v226, s[40:43], 0 offen offset:2048  lds
    v_rcp_f32 v50, v50
    buffer_load_dwordx4 v227, s[44:47], 0 offen offset:3072  lds
    v_rcp_f32 v51, v51
    v_mfma_f32_32x32x16_bf16 v[16:31], v[88:91], v[108:111], v[16:31]
    v_pk_mul_f32 v[48:49], v[48:49], v[32:33]
    v_pk_mul_f32 v[50:51], v[50:51], v[34:35]
    v_cvt_pk_bf16_f32 v64, v48, v49
    v_mfma_f32_32x32x16_bf16 v[16:31], v[92:95], v[112:115], v[16:31]
    v_cvt_pk_bf16_f32 v65, v50, v51
    v_mfma_f32_32x32x16_bf16 v[16:31], v[96:99], v[140:143], v[16:31]
    s_nop 10
    s_branch K_XT1
K_XAH0_8:
    s_sub_u32 s84, s84, 1
    s_cmp_eq_u32 s84, 0
    s_cselect_b32 s75, s77, s76
    v_exp_f32 v48, v16
    v_mfma_f32_32x32x16_bf16 v[164:179], v[72:75], v[64:67], v[164:179]
    v_and_b32 v247, 0x38, v229
    v_lshl_add_u32 v248, v247, 1, s75
    ds_read_b96 v[240:242], v248 offset:128
    v_bfe_u32 v253, v228, 7, 15
    v_exp_f32 v49, v17
    v_exp_f32 v50, v18
    s_cmp_lg_u32 s84, s95
    s_cbranch_scc1 KP7
    s_setprio 1
KP7:
    v_exp_f32 v51, v19
    v_mfma_f32_32x32x16_bf16 v[164:179], v[76:79], v[68:71], v[164:179]
    v_exp_f32 v52, v20
    ds_read_b64_tr_b16 v[72:73], v220 offset:0
    ds_read_b64_tr_b16 v[74:75], v220 offset:512
    v_exp_f32 v53, v21
    ds_read_b64_tr_b16 v[76:77], v220 offset:1024
    ds_read_b64_tr_b16 v[78:79], v220 offset:1536
    v_exp_f32 v54, v22
    v_exp_f32 v55, v23
    v_pk_add_f32 v[48:49], v[48:49], 1.0 op_sel_hi:[1,0]
    v_pk_add_f32 v[50:51], v[50:51], 1.0 op_sel_hi:[1,0]
    v_pk_add_f32 v[52:53], v[52:53], 1.0 op_sel_hi:[1,0]
    v_pk_add_f32 v[54:55], v[54:55], 1.0 op_sel_hi:[1,0]
    v_rcp_f32 v48, v48
    v_mfma_f32_32x32x16_bf16 v[32:47], v[96:99], v[136:139], 0
    v_rcp_f32 v49, v49
    s_waitcnt vmcnt(4) lgkmcnt(4)
    s_mov_b64 exec, s[70:71]
    ds_read_b128 v[96:99], v248
    s_mov_b64 exec, s[72:73]
    v_sub_f32 v240, v240, v232
    v_sub_f32 v241, v241, v233
    v_sub_f32 v242, v242, v234
    v_cvt_pk_bf16_f32 v244, 1.0, v240
    v_cvt_pk_bf16_f32 v245, v241, v242
    v_dot2_f32_bf16 v252, v244, v244, -1.0
    v_dot2_f32_bf16 v252, v245, v245, v252
    ds_read2st64_b32 v[96:97], v231 offset0:74 offset1:148
    ds_write_b64 v246, v[250:251]
    v_add_u32 v246, v247, v221
    ds_write_b64 v246, v[244:245]
    buffer_load_dwordx3 v[232:234], v253, s[12:15], 0 idxen sc1
    v_cvt_pk_bf16_f32 v98, v252, v252
    s_mov_b64 exec, -1
    v_rcp_f32 v50, v50
    v_add_u32 v249, s78, v222
    v_add_u32 v231, s78, v223
    ds_read_b128 v[224:227], v249
    ds_read_b32 v229, v231
    s_add_u32 s78, s78, 128
    s_cmp_eq_u32 s78, s79
    s_cselect_b32 s78, s80, s78
    s_cselect_b32 s79, s81, s79
    s_cselect_b32 s80, s82, s80
    s_cselect_b32 s81, s83, s81
    v_rcp_f32 v51, v51
    v_mfma_f32_32x32x16_bf16 v[32:47], v[80:83], v[116:119], v[32:47]
    v_rcp_f32 v52, v52
    v_rcp_f32 v53, v53
    v_rcp_f32 v54, v54
    v_mfma_f32_32x32x16_bf16 v[32:47], v[84:87], v[120:123], v[32:47]
    v_rcp_f32 v55, v55
    v_pk_mul_f32 v[48:49], v[48:49], v[16:17]
    v_pk_mul_f32 v[50:51], v[50:51], v[18:19]
    v_pk_mul_f32 v[52:53], v[52:53], v[20:21]
    v_pk_mul_f32 v[54:55], v[54:55], v[22:23]
    v_cvt_pk_bf16_f32 v64, v48, v49
    v_mfma_f32_32x32x16_bf16 v[32:47], v[88:91], v[124:127], v[32:47]
    v_cvt_pk_bf16_f32 v65, v50, v51
    v_cvt_pk_bf16_f32 v66, v52, v53
    s_cmp_lg_u32 s84, s101
    s_cbranch_scc1 KP8
    s_setprio 1
KP8:
    v_mfma_f32_32x32x16_bf16 v[32:47], v[92:95], v[128:131], v[32:47]
    v_cvt_pk_bf16_f32 v67, v54, v55
    ds_read_b128 v[80:83], v216 offset:4096
    ds_read_b128 v[84:87], v217 offset:4096
    ds_read_b128 v[88:91], v218 offset:4096
    ds_read_b128 v[92:95], v219 offset:4096
    s_waitcnt lgkmcnt(10)
    s_nop 5
    v_exp_f32 v48, v32
    v_mfma_f32_32x32x16_bf16 v[148:163], v[72:75], v[64:67], v[148:163]
    s_add_u32 m0, s86, 4096
    v_exp_f32 v49, v33
    s_waitcnt lgkmcnt(5)
    v_and_or_b32 v224, v224, s74, v212
    v_and_or_b32 v225, v225, s74, v213
    v_and_or_b32 v226, v226, s74, v214
    v_and_or_b32 v227, v227, s74, v215
    v_exp_f32 v50, v34
    v_exp_f32 v51, v35
    v_exp_f32 v52, v36
    s_waitcnt lgkmcnt(0)
    v_mfma_f32_32x32x16_bf16 v[16:31], v[80:83], v[100:103], 0
    v_exp_f32 v53, v37
    buffer_load_dwordx4 v224, s[32:35], 0 offen offset:0  lds
    v_exp_f32 v54, v38
    buffer_load_dwordx4 v225, s[36:39], 0 offen offset:1024  lds
    v_exp_f32 v55, v39
    buffer_load_dwordx4 v226, s[40:43], 0 offen offset:2048  lds
    v_pk_add_f32 v[48:49], v[48:49], 1.0 op_sel_hi:[1,0]
    v_pk_add_f32 v[50:51], v[50:51], 1.0 op_sel_hi:[1,0]
    v_pk_add_f32 v[52:53], v[52:53], 1.0 op_sel_hi:[1,0]
    v_pk_add_f32 v[54:55], v[54:55], 1.0 op_sel_hi:[1,0]
    v_rcp_f32 v48, v48
    v_mfma_f32_32x32x16_bf16 v[16:31], v[84:87], v[104:107], v[16:31]
    v_rcp_f32 v49, v49
    buffer_load_dwordx4 v227, s[44:47], 0 offen offset:3072  lds
    v_rcp_f32 v50, v50
    v_rcp_f32 v51, v51
    v_mfma_f32_32x32x16_bf16 v[16:31], v[88:91], v[108:111], v[16:31]
    v_rcp_f32 v52, v52
    v_rcp_f32 v53, v53
    v_rcp_f32 v54, v54
    v_mfma_f32_32x32x16_bf16 v[16:31], v[92:95], v[112:115], v[16:31]
    v_rcp_f32 v55, v55
    v_pk_mul_f32 v[48:49], v[48:49], v[32:33]
    v_pk_mul_f32 v[50:51], v[50:51], v[34:35]
    v_pk_mul_f32 v[52:53], v[52:53], v[36:37]
    v_pk_mul_f32 v[54:55], v[54:55], v[38:39]
    v_cvt_pk_bf16_f32 v64, v48, v49
    v_mfma_f32_32x32x16_bf16 v[16:31], v[96:99], v[140:143], v[16:31]
    v_cvt_pk_bf16_f32 v65, v50, v51
    v_cvt_pk_bf16_f32 v66, v52, v53
    v_cvt_pk_bf16_f32 v67, v54, v55
    s_nop 10
    s_branch K_XT1
K_XAH0_12:
    s_sub_u32 s84, s84, 1
    s_cmp_eq_u32 s84, 0
    s_cselect_b32 s75, s77, s76
    v_exp_f32 v48, v16
    v_mfma_f32_32x32x16_bf16 v[164:179], v[72:75], v[64:67], v[164:179]
    v_and_b32 v247, 0x38, v229
    v_lshl_add_u32 v248, v247, 1, s75
    ds_read_b96 v[240:242], v248 offset:128
    v_bfe_u32 v253, v228, 7, 15
    v_exp_f32 v49, v17
    v_exp_f32 v50, v18
    s_cmp_lg_u32 s84, s95
    s_cbranch_scc1 KP9
    s_setprio 1
KP9:
    v_exp_f32 v51, v19
    v_mfma_f32_32x32x16_bf16 v[164:179], v[76:79], v[68:71], v[164:179]
    v_exp_f32 v52, v20
    ds_read_b64_tr_b16 v[72:73], v220 offset:0
    ds_read_b64_tr_b16 v[74:75], v220 offset:512
    v_exp_f32 v53, v21
    ds_read_b64_tr_b16 v[76:77], v220 offset:1024
    ds_read_b64_tr_b16 v[78:79], v220 offset:1536
    v_exp_f32 v54, v22
    v_mfma_f32_32x32x16_bf16 v[32:47], v[96:99], v[136:139], 0
    v_exp_f32 v55, v23
    v_exp_f32 v56, v24
    v_exp_f32 v57, v25
    v_exp_f32 v58, v26
    v_exp_f32 v59, v27
    s_waitcnt vmcnt(4) lgkmcnt(4)
    s_mov_b64 exec, s[70:71]
    ds_read_b128 v[96:99], v248
    s_mov_b64 exec, s[72:73]
    v_sub_f32 v240, v240, v232
    v_sub_f32 v241, v241, v233
    v_sub_f32 v242, v242, v234
    v_cvt_pk_bf16_f32 v244, 1.0, v240
    v_cvt_pk_bf16_f32 v245, v241, v242
    v_dot2_f32_bf16 v252, v244, v244, -1.0
    v_dot2_f32_bf16 v252, v245, v245, v252
    ds_read2st64_b32 v[96:97], v231 offset0:74 offset1:148
    ds_write_b64 v246, v[250:251]
    v_add_u32 v246, v247, v221
    ds_write_b64 v246, v[244:245]
    buffer_load_dwordx3 v[232:234], v253, s[12:15], 0 idxen sc1
    v_cvt_pk_bf16_f32 v98, v252, v252
    s_mov_b64 exec, -1
    v_pk_add_f32 v[48:49], v[48:49], 1.0 op_sel_hi:[1,0]
    v_pk_add_f32 v[50:51], v[50:51], 1.0 op_sel_hi:[1,0]
    v_add_u32 v249, s78, v222
    v_add_u32 v231, s78, v223
    ds_read_b128 v[224:227], v249
    ds_read_b32 v229, v231
    s_add_u32 s78, s78, 128
    s_cmp_eq_u32 s78, s79
    s_cselect_b32 s78, s80, s78
    s_cselect_b32 s79, s81, s79
    s_cselect_b32 s80, s82, s80
    s_cselect_b32 s81, s83, s81
    v_pk_add_f32 v[52:53], v[52:53], 1.0 op_sel_hi:[1,0]
    v_pk_add_f32 v[54:55], v[54:55], 1.0 op_sel_hi:[1,0]
    v_pk_add_f32 v[56:57], v[56:57], 1.0 op_sel_hi:[1,0]
    v_pk_add_f32 v[58:59], v[58:59], 1.0 op_sel_hi:[1,0]
    v_rcp_f32 v48, v48
    v_mfma_f32_32x32x16_bf16 v[32:47], v[80:83], v[116:119], v[32:47]
    v_rcp_f32 v49, v49
    v_rcp_f32 v50, v50
    v_rcp_f32 v51, v51
    v_mfma_f32_32x32x16_bf16 v[32:47], v[84:87], v[120:123], v[32:47]
    v_rcp_f32 v52, v52
    v_rcp_f32 v53, v53
    v_rcp_f32 v54, v54
    v_mfma_f32_32x32x16_bf16 v[32:47], v[88:91], v[124:127], v[32:47]
    v_rcp_f32 v55, v55
    v_rcp_f32 v56, v56
    v_rcp_f32 v57, v57
    v_rcp_f32 v58, v58
    v_rcp_f32 v59, v59
    v_pk_mul_f32 v[48:49], v[48:49], v[16:17]
    v_pk_mul_f32 v[50:51], v[50:51], v[18:19]
    v_pk_mul_f32 v[52:53], v[52:53], v[20:21]
    v_pk_mul_f32 v[54:55], v[54:55], v[22:23]
    v_pk_mul_f32 v[56:57], v[56:57], v[24:25]
    v_pk_mul_f32 v[58:59], v[58:59], v[26:27]
    v_cvt_pk_bf16_f32 v64, v48, v49
    v_mfma_f32_32x32x16_bf16 v[32:47], v[92:95], v[128:131], v[32:47]
    v_cvt_pk_bf16_f32 v65, v50, v51
    ds_read_b128 v[80:83], v216 offset:4096
    ds_read_b128 v[84:87], v217 offset:4096
    ds_read_b128 v[88:91], v218 offset:4096
    ds_read_b128 v[92:95], v219 offset:4096
    v_cvt_pk_bf16_f32 v66, v52, v53
    v_cvt_pk_bf16_f32 v67, v54, v55
    v_cvt_pk_bf16_f32 v68, v56, v57
    s_cmp_lg_u32 s84, s101
    s_cbranch_scc1 KP10
    s_setprio 1
KP10:
    v_cvt_pk_bf16_f32 v69, v58, v59
    s_waitcnt lgkmcnt(10)
    v_exp_f32 v48, v32
    v_mfma_f32_32x32x16_bf16 v[148:163], v[72:75], v[64:67], v[148:163]
    s_add_u32 m0, s86, 4096
    v_exp_f32 v49, v33
    s_waitcnt lgkmcnt(5)
    v_and_or_b32 v224, v224, s74, v212
    v_and_or_b32 v225, v225, s74, v213
    v_and_or_b32 v226, v226, s74, v214
    v_and_or_b32 v227, v227, s74, v215
    v_exp_f32 v50, v34
    v_exp_f32 v51, v35
    v_mfma_f32_32x32x16_bf16 v[148:163], v[76:79], v[68:71], v[148:163]
    v_exp_f32 v52, v36
    v_exp_f32 v53, v37
    v_exp_f32 v54, v38
    s_waitcnt lgkmcnt(0)
    v_mfma_f32_32x32x16_bf16 v[16:31], v[80:83], v[100:103], 0
    v_exp_f32 v55, v39
    buffer_load_dwordx4 v224, s[32:35], 0 offen offset:0  lds
    v_exp_f32 v56, v40
    buffer_load_dwordx4 v225, s[36:39], 0 offen offset:1024  lds
    v_exp_f32 v57, v41
    v_exp_f32 v58, v42
    buffer_load_dwordx4 v226, s[40:43], 0 offen offset:2048  lds
    v_exp_f32 v59, v43
    buffer_load_dwordx4 v227, s[44:47], 0 offen offset:3072  lds
    v_pk_add_f32 v[48:49], v[48:49], 1.0 op_sel_hi:[1,0]
    v_pk_add_f32 v[50:51], v[50:51], 1.0 op_sel_hi:[1,0]
    v_pk_add_f32 v[52:53], v[52:53], 1.0 op_sel_hi:[1,0]
    v_pk_add_f32 v[54:55], v[54:55], 1.0 op_sel_hi:[1,0]
    v_pk_add_f32 v[56:57], v[56:57], 1.0 op_sel_hi:[1,0]
    v_pk_add_f32 v[58:59], v[58:59], 1.0 op_sel_hi:[1,0]
    v_rcp_f32 v48, v48
    v_mfma_f32_32x32x16_bf16 v[16:31], v[84:87], v[104:107], v[16:31]
    v_rcp_f32 v49, v49
    v_rcp_f32 v50, v50
    v_rcp_f32 v51, v51
    v_mfma_f32_32x32x16_bf16 v[16:31], v[88:91], v[108:111], v[16:31]
    v_rcp_f32 v52, v52
    v_rcp_f32 v53, v53
    v_rcp_f32 v54, v54
    v_mfma_f32_32x32x16_bf16 v[16:31], v[92:95], v[112:115], v[16:31]
    v_rcp_f32 v55, v55
    v_rcp_f32 v56, v56
    v_rcp_f32 v57, v57
    v_rcp_f32 v58, v58
    v_rcp_f32 v59, v59
    v_pk_mul_f32 v[48:49], v[48:49], v[32:33]
    v_pk_mul_f32 v[50:51], v[50:51], v[34:35]
    v_pk_mul_f32 v[52:53], v[52:53], v[36:37]
    v_pk_mul_f32 v[54:55], v[54:55], v[38:39]
    v_pk_mul_f32 v[56:57], v[56:57], v[40:41]
    v_pk_mul_f32 v[58:59], v[58:59], v[42:43]
    v_cvt_pk_bf16_f32 v64, v48, v49
    v_mfma_f32_32x32x16_bf16 v[16:31], v[96:99], v[140:143], v[16:31]
    v_cvt_pk_bf16_f32 v65, v50, v51
    v_cvt_pk_bf16_f32 v66, v52, v53
    v_cvt_pk_bf16_f32 v67, v54, v55
    v_cvt_pk_bf16_f32 v68, v56, v57
    v_cvt_pk_bf16_f32 v69, v58, v59
    s_nop 10
    s_branch K_XT1
K_XAH1:
    s_cmp_eq_u32 s56, 12
    s_cbranch_scc1 K_XAH1_12
    s_cmp_eq_u32 s56, 8
    s_cbranch_scc1 K_XAH1_8
K_XAH1_4:
    s_sub_u32 s84, s84, 1
    s_cmp_eq_u32 s84, 0
    s_cselect_b32 s75, s77, s76
    v_exp_f32 v48, v16
    v_mfma_f32_32x32x16_bf16 v[164:179], v[72:75], v[64:67], v[164:179]
    v_and_b32 v247, 0x38, v228
    v_lshl_add_u32 v248, v247, 1, s75
    ds_read_b96 v[240:242], v248 offset:128
    v_bfe_u32 v253, v229, 7, 15
    v_exp_f32 v49, v17
    v_exp_f32 v50, v18
    s_cmp_lg_u32 s84, s95
    s_cbranch_scc1 KP11
    s_setprio 1
KP11:
    v_exp_f32 v51, v19
    v_mfma_f32_32x32x16_bf16 v[164:179], v[76:79], v[68:71], v[164:179]
    v_pk_add_f32 v[48:49], v[48:49], 1.0 op_sel_hi:[1,0]
    ds_read_b64_tr_b16 v[72:73], v220 offset:0
    ds_read_b64_tr_b16 v[74:75], v220 offset:512
    v_pk_add_f32 v[50:51], v[50:51], 1.0 op_sel_hi:[1,0]
    ds_read_b64_tr_b16 v[76:77], v220 offset:1024
    ds_read_b64_tr_b16 v[78:79], v220 offset:1536
    v_rcp_f32 v48, v48
    v_mfma_f32_32x32x16_bf16 v[32:47], v[96:99], v[136:139], 0
    v_rcp_f32 v49, v49
    s_waitcnt vmcnt(4) lgkmcnt(4)
    s_mov_b64 exec, s[70:71]
    ds_read_b128 v[96:99], v248
    s_mov_b64 exec, s[72:73]
    v_sub_f32 v240, v240, v232
    v_sub_f32 v241, v241, v233
    v_sub_f32 v242, v242, v234
    v_cvt_pk_bf16_f32 v244, 1.0, v240
    v_cvt_pk_bf16_f32 v245, v241, v242
    v_dot2_f32_bf16 v252, v244, v244, -1.0
    v_dot2_f32_bf16 v252, v245, v245, v252
    ds_read2st64_b32 v[96:97], v230 offset0:74 offset1:148
    ds_write_b64 v246, v[250:251]
    v_add_u32 v246, v247, v221
    ds_write_b64 v246, v[244:245]
    buffer_load_dwordx3 v[232:234], v253, s[12:15], 0 idxen sc1
    v_cvt_pk_bf16_f32 v98, v252, v252
    s_mov_b64 exec, -1
    v_rcp_f32 v50, v50
    v_add_u32 v249, s78, v222
    v_add_u32 v230, s78, v223
    ds_read_b128 v[224:227], v249
    ds_read_b32 v228, v230
    s_add_u32 s78, s78, 128
    s_cmp_eq_u32 s78, s79
    s_cselect_b32 s78, s80, s78
    s_cselect_b32 s79, s81, s79
    s_cselect_b32 s80, s82, s80
    s_cselect_b32 s81, s83, s81
    v_rcp_f32 v51, v51
    v_mfma_f32_32x32x16_bf16 v[32:47], v[80:83], v[116:119], v[32:47]
    v_pk_mul_f32 v[48:49], v[48:49], v[16:17]
    v_pk_mul_f32 v[50:51], v[50:51], v[18:19]
    v_cvt_pk_bf16_f32 v64, v48, v49
    s_cmp_lg_u32 s84, s101
    s_cbranch_scc1 KP12
    s_setprio 1
KP12:
    v_mfma_f32_32x32x16_bf16 v[32:47], v[84:87], v[120:123], v[32:47]
    v_cvt_pk_bf16_f32 v65, v50, v51
    v_mfma_f32_32x32x16_bf16 v[32:47], v[88:91], v[124:127], v[32:47]
    v_mfma_f32_32x32x16_bf16 v[32:47], v[92:95], v[128:131], v[32:47]
    ds_read_b128 v[80:83], v216 offset:0
    ds_read_b128 v[84:87], v217 offset:0
    ds_read_b128 v[88:91], v218 offset:0
    ds_read_b128 v[92:95], v219 offset:0
    s_waitcnt lgkmcnt(10)
    s_nop 6
    v_exp_f32 v48, v32
    v_mfma_f32_32x32x16_bf16 v[148:163], v[72:75], v[64:67], v[148:163]
    s_add_u32 m0, s86, 0
    v_exp_f32 v49, v33
    s_waitcnt lgkmcnt(5)
    v_and_or_b32 v224, v224, s74, v212
    v_and_or_b32 v225, v225, s74, v213
    v_and_or_b32 v226, v226, s74, v214
    v_and_or_b32 v227, v227, s74, v215
    v_exp_f32 v50, v34
    s_waitcnt lgkmcnt(0)
    v_mfma_f32_32x32x16_bf16 v[16:31], v[80:83], v[100:103], 0
    v_exp_f32 v51, v35
    buffer_load_dwordx4 v224, s[32:35], 0 offen offset:0  lds
    v_pk_add_f32 v[48:49], v[48:49], 1.0 op_sel_hi:[1,0]
    v_pk_add_f32 v[50:51], v[50:51], 1.0 op_sel_hi:[1,0]
    v_rcp_f32 v48, v48
    v_mfma_f32_32x32x16_bf16 v[16:31], v[84:87], v[104:107], v[16:31]
    buffer_load_dwordx4 v225, s[36:39], 0 offen offset:1024  lds
    v_rcp_f32 v49, v49
    buffer_load_dwordx4 v226, s[40:43], 0 offen offset:2048  lds
    v_rcp_f32 v50, v50
    buffer_load_dwordx4 v227, s[44:47], 0 offen offset:3072  lds
    v_rcp_f32 v51, v51
    v_mfma_f32_32x32x16_bf16 v[16:31], v[88:91], v[108:111], v[16:31]
    v_pk_mul_f32 v[48:49], v[48:49], v[32:33]
    v_pk_mul_f32 v[50:51], v[50:51], v[34:35]
    v_cvt_pk_bf16_f32 v64, v48, v49
    v_mfma_f32_32x32x16_bf16 v[16:31], v[92:95], v[112:115], v[16:31]
    v_cvt_pk_bf16_f32 v65, v50, v51
    v_mfma_f32_32x32x16_bf16 v[16:31], v[96:99], v[140:143], v[16:31]
    s_nop 10
    s_branch K_XT0
K_XAH1_8:
    s_sub_u32 s84, s84, 1
    s_cmp_eq_u32 s84, 0
    s_cselect_b32 s75, s77, s76
    v_exp_f32 v48, v16
    v_mfma_f32_32x32x16_bf16 v[164:179], v[72:75], v[64:67], v[164:179]
    v_and_b32 v247, 0x38, v228
    v_lshl_add_u32 v248, v247, 1, s75
    ds_read_b96 v[240:242], v248 offset:128
    v_bfe_u32 v253, v229, 7, 15
    v_exp_f32 v49, v17
    v_exp_f32 v50, v18
    s_cmp_lg_u32 s84, s95
    s_cbranch_scc1 KP13
    s_setprio 1
KP13:
    v_exp_f32 v51, v19
    v_mfma_f32_32x32x16_bf16 v[164:179], v[76:79], v[68:71], v[164:179]
    v_exp_f32 v52, v20
    ds_read_b64_tr_b16 v[72:73], v220 offset:0
    ds_read_b64_tr_b16 v[74:75], v220 offset:512
    v_exp_f32 v53, v21
    ds_read_b64_tr_b16 v[76:77], v220 offset:1024
    ds_read_b64_tr_b16 v[78:79], v220 offset:1536
    v_exp_f32 v54, v22
    v_exp_f32 v55, v23
    v_pk_add_f32 v[48:49], v[48:49], 1.0 op_sel_hi:[1,0]
    v_pk_add_f32 v[50:51], v[50:51], 1.0 op_sel_hi:[1,0]
    v_pk_add_f32 v[52:53], v[52:53], 1.0 op_sel_hi:[1,0]
    v_pk_add_f32 v[54:55], v[54:55], 1.0 op_sel_hi:[1,0]
    v_rcp_f32 v48, v48
    v_mfma_f32_32x32x16_bf16 v[32:47], v[96:99], v[136:139], 0
    v_rcp_f32 v49, v49
    s_waitcnt vmcnt(4) lgkmcnt(4)
    s_mov_b64 exec, s[70:71]
    ds_read_b128 v[96:99], v248
    s_mov_b64 exec, s[72:73]
    v_sub_f32 v240, v240, v232
    v_sub_f32 v241, v241, v233
    v_sub_f32 v242, v242, v234
    v_cvt_pk_bf16_f32 v244, 1.0, v240
    v_cvt_pk_bf16_f32 v245, v241, v242
    v_dot2_f32_bf16 v252, v244, v244, -1.0
    v_dot2_f32_bf16 v252, v245, v245, v252
    ds_read2st64_b32 v[96:97], v230 offset0:74 offset1:148
    ds_write_b64 v246, v[250:251]
    v_add_u32 v246, v247, v221
    ds_write_b64 v246, v[244:245]
    buffer_load_dwordx3 v[232:234], v253, s[12:15], 0 idxen sc1
    v_cvt_pk_bf16_f32 v98, v252, v252
    s_mov_b64 exec, -1
    v_rcp_f32 v50, v50
    v_add_u32 v249, s78, v222
    v_add_u32 v230, s78, v223
    ds_read_b128 v[224:227], v249
    ds_read_b32 v228, v230
    s_add_u32 s78, s78, 128
    s_cmp_eq_u32 s78, s79
    s_cselect_b32 s78, s80, s78
    s_cselect_b32 s79, s81, s79
    s_cselect_b32 s80, s82, s80
    s_cselect_b32 s81, s83, s81
    v_rcp_f32 v51, v51
    v_mfma_f32_32x32x16_bf16 v[32:47], v[80:83], v[116:119], v[32:47]
    v_rcp_f32 v52, v52
    v_rcp_f32 v53, v53
    v_rcp_f32 v54, v54
    v_mfma_f32_32x32x16_bf16 v[32:47], v[84:87], v[120:123], v[32:47]
    v_rcp_f32 v55, v55
    v_pk_mul_f32 v[48:49], v[48:49], v[16:17]
    v_pk_mul_f32 v[50:51], v[50:51], v[18:19]
    v_pk_mul_f32 v[52:53], v[52:53], v[20:21]
    v_pk_mul_f32 v[54:55], v[54:55], v[22:23]
    v_cvt_pk_bf16_f32 v64, v48, v49
    v_mfma_f32_32x32x16_bf16 v[32:47], v[88:91], v[124:127], v[32:47]
    v_cvt_pk_bf16_f32 v65, v50, v51
    v_cvt_pk_bf16_f32 v66, v52, v53
    s_cmp_lg_u32 s84, s101
    s_cbranch_scc1 KP14
    s_setprio 1
KP14:
    v_mfma_f32_32x32x16_bf16 v[32:47], v[92:95], v[128:131], v[32:47]
    v_cvt_pk_bf16_f32 v67, v54, v55
    ds_read_b128 v[80:83], v216 offset:0
    ds_read_b128 v[84:87], v217 offset:0
    ds_read_b128 v[88:91], v218 offset:0
    ds_read_b128 v[92:95], v219 offset:0
    s_waitcnt lgkmcnt(10)
    s_nop 5
    v_exp_f32 v48, v32
    v_mfma_f32_32x32x16_bf16 v[148:163], v[72:75], v[64:67], v[148:163]
    s_add_u32 m0, s86, 0
    v_exp_f32 v49, v33
    s_waitcnt lgkmcnt(5)
    v_and_or_b32 v224, v224, s74, v212
    v_and_or_b32 v225, v225, s74, v213
    v_and_or_b32 v226, v226, s74, v214
    v_and_or_b32 v227, v227, s74, v215
    v_exp_f32 v50, v34
    v_exp_f32 v51, v35
    v_exp_f32 v52, v36
    s_waitcnt lgkmcnt(0)
    v_mfma_f32_32x32x16_bf16 v[16:31], v[80:83], v[100:103], 0
    v_exp_f32 v53, v37
    buffer_load_dwordx4 v224, s[32:35], 0 offen offset:0  lds
    v_exp_f32 v54, v38
    buffer_load_dwordx4 v225, s[36:39], 0 offen offset:1024  lds
    v_exp_f32 v55, v39
    buffer_load_dwordx4 v226, s[40:43], 0 offen offset:2048  lds
    v_pk_add_f32 v[48:49], v[48:49], 1.0 op_sel_hi:[1,0]
    v_pk_add_f32 v[50:51], v[50:51], 1.0 op_sel_hi:[1,0]
    v_pk_add_f32 v[52:53], v[52:53], 1.0 op_sel_hi:[1,0]
    v_pk_add_f32 v[54:55], v[54:55], 1.0 op_sel_hi:[1,0]
    v_rcp_f32 v48, v48
    v_mfma_f32_32x32x16_bf16 v[16:31], v[84:87], v[104:107], v[16:31]
    v_rcp_f32 v49, v49
    buffer_load_dwordx4 v227, s[44:47], 0 offen offset:3072  lds
    v_rcp_f32 v50, v50
    v_rcp_f32 v51, v51
    v_mfma_f32_32x32x16_bf16 v[16:31], v[88:91], v[108:111], v[16:31]
    v_rcp_f32 v52, v52
    v_rcp_f32 v53, v53
    v_rcp_f32 v54, v54
    v_mfma_f32_32x32x16_bf16 v[16:31], v[92:95], v[112:115], v[16:31]
    v_rcp_f32 v55, v55
    v_pk_mul_f32 v[48:49], v[48:49], v[32:33]
    v_pk_mul_f32 v[50:51], v[50:51], v[34:35]
    v_pk_mul_f32 v[52:53], v[52:53], v[36:37]
    v_pk_mul_f32 v[54:55], v[54:55], v[38:39]
    v_cvt_pk_bf16_f32 v64, v48, v49
    v_mfma_f32_32x32x16_bf16 v[16:31], v[96:99], v[140:143], v[16:31]
    v_cvt_pk_bf16_f32 v65, v50, v51
    v_cvt_pk_bf16_f32 v66, v52, v53
    v_cvt_pk_bf16_f32 v67, v54, v55
    s_nop 10
    s_branch K_XT0
K_XAH1_12:
    s_sub_u32 s84, s84, 1
    s_cmp_eq_u32 s84, 0
    s_cselect_b32 s75, s77, s76
    v_exp_f32 v48, v16
    v_mfma_f32_32x32x16_bf16 v[164:179], v[72:75], v[64:67], v[164:179]
    v_and_b32 v247, 0x38, v228
    v_lshl_add_u32 v248, v247, 1, s75
    ds_read_b96 v[240:242], v248 offset:128
    v_bfe_u32 v253, v229, 7, 15
    v_exp_f32 v49, v17
    v_exp_f32 v50, v18
    s_cmp_lg_u32 s84, s95
    s_cbranch_scc1 KP15
    s_setprio 1
KP15:
    v_exp_f32 v51, v19
    v_mfma_f32_32x32x16_bf16 v[164:179], v[76:79], v[68:71], v[164:179]
    v_exp_f32 v52, v20
    ds_read_b64_tr_b16 v[72:73], v220 offset:0
    ds_read_b64_tr_b16 v[74:75], v220 offset:512
    v_exp_f32 v53, v21
    ds_read_b64_tr_b16 v[76:77], v220 offset:1024
    ds_read_b64_tr_b16 v[78:79], v220 offset:1536
    v_exp_f32 v54, v22
    v_mfma_f32_32x32x16_bf16 v[32:47], v[96:99], v[136:139], 0
    v_exp_f32 v55, v23
    v_exp_f32 v56, v24
    v_exp_f32 v57, v25
    v_exp_f32 v58, v26
    v_exp_f32 v59, v27
    s_waitcnt vmcnt(4) lgkmcnt(4)
    s_mov_b64 exec, s[70:71]
    ds_read_b128 v[96:99], v248
    s_mov_b64 exec, s[72:73]
    v_sub_f32 v240, v240, v232
    v_sub_f32 v241, v241, v233
    v_sub_f32 v242, v242, v234
    v_cvt_pk_bf16_f32 v244, 1.0, v240
    v_cvt_pk_bf16_f32 v245, v241, v242
    v_dot2_f32_bf16 v252, v244, v244, -1.0
    v_dot2_f32_bf16 v252, v245, v245, v252
    ds_read2st64_b32 v[96:97], v230 offset0:74 offset1:148
    ds_write_b64 v246, v[250:251]
    v_add_u32 v246, v247, v221
    ds_write_b64 v246, v[244:245]
    buffer_load_dwordx3 v[232:234], v253, s[12:15], 0 idxen sc1
    v_cvt_pk_bf16_f32 v98, v252, v252
    s_mov_b64 exec, -1
    v_pk_add_f32 v[48:49], v[48:49], 1.0 op_sel_hi:[1,0]
    v_pk_add_f32 v[50:51], v[50:51], 1.0 op_sel_hi:[1,0]
    v_add_u32 v249, s78, v222
    v_add_u32 v230, s78, v223
    ds_read_b128 v[224:227], v249
    ds_read_b32 v228, v230
    s_add_u32 s78, s78, 128
    s_cmp_eq_u32 s78, s79
    s_cselect_b32 s78, s80, s78
    s_cselect_b32 s79, s81, s79
    s_cselect_b32 s80, s82, s80
    s_cselect_b32 s81, s83, s81
    v_pk_add_f32 v[52:53], v[52:53], 1.0 op_sel_hi:[1,0]
    v_pk_add_f32 v[54:55], v[54:55], 1.0 op_sel_hi:[1,0]
    v_pk_add_f32 v[56:57], v[56:57], 1.0 op_sel_hi:[1,0]
    v_pk_add_f32 v[58:59], v[58:59], 1.0 op_sel_hi:[1,0]
    v_rcp_f32 v48, v48
    v_mfma_f32_32x32x16_bf16 v[32:47], v[80:83], v[116:119], v[32:47]
    v_rcp_f32 v49, v49
    v_rcp_f32 v50, v50
    v_rcp_f32 v51, v51
    v_mfma_f32_32x32x16_bf16 v[32:47], v[84:87], v[120:123], v[32:47]
    v_rcp_f32 v52, v52
    v_rcp_f32 v53, v53
    v_rcp_f32 v54, v54
    v_mfma_f32_32x32x16_bf16 v[32:47], v[88:91], v[124:127], v[32:47]
    v_rcp_f32 v55, v55
    v_rcp_f32 v56, v56
    v_rcp_f32 v57, v57
    v_rcp_f32 v58, v58
    v_rcp_f32 v59, v59
    v_pk_mul_f32 v[48:49], v[48:49], v[16:17]
    v_pk_mul_f32 v[50:51], v[50:51], v[18:19]
    v_pk_mul_f32 v[52:53], v[52:53], v[20:21]
    v_pk_mul_f32 v[54:55], v[54:55], v[22:23]
    v_pk_mul_f32 v[56:57], v[56:57], v[24:25]
    v_pk_mul_f32 v[58:59], v[58:59], v[26:27]
    v_cvt_pk_bf16_f32 v64, v48, v49
    v_mfma_f32_32x32x16_bf16 v[32:47], v[92:95], v[128:131], v[32:47]
    v_cvt_pk_bf16_f32 v65, v50, v51
    ds_read_b128 v[80:83], v216 offset:0
    ds_read_b128 v[84:87], v217 offset:0
    ds_read_b128 v[88:91], v218 offset:0
    ds_read_b128 v[92:95], v219 offset:0
    v_cvt_pk_bf16_f32 v66, v52, v53
    v_cvt_pk_bf16_f32 v67, v54, v55
    v_cvt_pk_bf16_f32 v68, v56, v57
    s_cmp_lg_u32 s84, s101
    s_cbranch_scc1 KP16
    s_setprio 1
KP16:
    v_cvt_pk_bf16_f32 v69, v58, v59
    s_waitcnt lgkmcnt(10)
    v_exp_f32 v48, v32
    v_mfma_f32_32x32x16_bf16 v[148:163], v[72:75], v[64:67], v[148:163]
    s_add_u32 m0, s86, 0
    v_exp_f32 v49, v33
    s_waitcnt lgkmcnt(5)
    v_and_or_b32 v224, v224, s74, v212
    v_and_or_b32 v225, v225, s74, v213
    v_and_or_b32 v226, v226, s74, v214
    v_and_or_b32 v227, v227, s74, v215
    v_exp_f32 v50, v34
    v_exp_f32 v51, v35
    v_mfma_f32_32x32x16_bf16 v[148:163], v[76:79], v[68:71], v[148:163]
    v_exp_f32 v52, v36
    v_exp_f32 v53, v37
    v_exp_f32 v54, v38
    s_waitcnt lgkmcnt(0)
    v_mfma_f32_32x32x16_bf16 v[16:31], v[80:83], v[100:103], 0
    v_exp_f32 v55, v39
    buffer_load_dwordx4 v224, s[32:35], 0 offen offset:0  lds
    v_exp_f32 v56, v40
    buffer_load_dwordx4 v225, s[36:39], 0 offen offset:1024  lds
    v_exp_f32 v57, v41
    v_exp_f32 v58, v42
    buffer_load_dwordx4 v226, s[40:43], 0 offen offset:2048  lds
    v_exp_f32 v59, v43
    buffer_load_dwordx4 v227, s[44:47], 0 offen offset:3072  lds
    v_pk_add_f32 v[48:49], v[48:49], 1.0 op_sel_hi:[1,0]
    v_pk_add_f32 v[50:51], v[50:51], 1.0 op_sel_hi:[1,0]
    v_pk_add_f32 v[52:53], v[52:53], 1.0 op_sel_hi:[1,0]
    v_pk_add_f32 v[54:55], v[54:55], 1.0 op_sel_hi:[1,0]
    v_pk_add_f32 v[56:57], v[56:57], 1.0 op_sel_hi:[1,0]
    v_pk_add_f32 v[58:59], v[58:59], 1.0 op_sel_hi:[1,0]
    v_rcp_f32 v48, v48
    v_mfma_f32_32x32x16_bf16 v[16:31], v[84:87], v[104:107], v[16:31]
    v_rcp_f32 v49, v49
    v_rcp_f32 v50, v50
    v_rcp_f32 v51, v51
    v_mfma_f32_32x32x16_bf16 v[16:31], v[88:91], v[108:111], v[16:31]
    v_rcp_f32 v52, v52
    v_rcp_f32 v53, v53
    v_rcp_f32 v54, v54
    v_mfma_f32_32x32x16_bf16 v[16:31], v[92:95], v[112:115], v[16:31]
    v_rcp_f32 v55, v55
    v_rcp_f32 v56, v56
    v_rcp_f32 v57, v57
    v_rcp_f32 v58, v58
    v_rcp_f32 v59, v59
    v_pk_mul_f32 v[48:49], v[48:49], v[32:33]
    v_pk_mul_f32 v[50:51], v[50:51], v[34:35]
    v_pk_mul_f32 v[52:53], v[52:53], v[36:37]
    v_pk_mul_f32 v[54:55], v[54:55], v[38:39]
    v_pk_mul_f32 v[56:57], v[56:57], v[40:41]
    v_pk_mul_f32 v[58:59], v[58:59], v[42:43]
    v_cvt_pk_bf16_f32 v64, v48, v49
    v_mfma_f32_32x32x16_bf16 v[16:31], v[96:99], v[140:143], v[16:31]
    v_cvt_pk_bf16_f32 v65, v50, v51
    v_cvt_pk_bf16_f32 v66, v52, v53
    v_cvt_pk_bf16_f32 v67, v54, v55
    v_cvt_pk_bf16_f32 v68, v56, v57
    v_cvt_pk_bf16_f32 v69, v58, v59
    s_nop 10
    s_branch K_XT0
K_YT0:
    s_waitcnt lgkmcnt(10)
    v_exp_f32 v48, v32
    v_mfma_f32_32x32x16_bf16 v[148:163], v[72:75], v[64:67], v[148:163]
    s_add_u32 m0, s86, 4096
    v_exp_f32 v49, v33
    s_waitcnt lgkmcnt(5)
    v_and_or_b32 v224, v224, s74, v212
    v_and_or_b32 v225, v225, s74, v213
    v_and_or_b32 v226, v226, s74, v214
    v_and_or_b32 v227, v227, s74, v215
    v_exp_f32 v50, v34
    v_exp_f32 v51, v35
    v_mfma_f32_32x32x16_bf16 v[148:163], v[76:79], v[68:71], v[148:163]
    v_exp_f32 v52, v36
    v_exp_f32 v53, v37
    v_exp_f32 v54, v38
    s_waitcnt lgkmcnt(0)
    v_mfma_f32_32x32x16_bf16 v[16:31], v[80:83], v[100:103], 0
    v_exp_f32 v55, v39
    buffer_load_dwordx4 v224, s[32:35], 0 offen offset:0  lds
    v_exp_f32 v56, v40
    buffer_load_dwordx4 v225, s[36:39], 0 offen offset:1024  lds
    v_exp_f32 v57, v41
    v_exp_f32 v58, v42
    buffer_load_dwordx4 v226, s[40:43], 0 offen offset:2048  lds
    v_exp_f32 v59, v43
    buffer_load_dwordx4 v227, s[44:47], 0 offen offset:3072  lds
    v_exp_f32 v60, v44
    v_exp_f32 v61, v45
    v_exp_f32 v62, v46
    v_exp_f32 v63, v47
    v_pk_add_f32 v[48:49], v[48:49], 1.0 op_sel_hi:[1,0]
    v_pk_add_f32 v[50:51], v[50:51], 1.0 op_sel_hi:[1,0]
    v_pk_add_f32 v[52:53], v[52:53], 1.0 op_sel_hi:[1,0]
    v_pk_add_f32 v[54:55], v[54:55], 1.0 op_sel_hi:[1,0]
    v_pk_add_f32 v[56:57], v[56:57], 1.0 op_sel_hi:[1,0]
    v_pk_add_f32 v[58:59], v[58:59], 1.0 op_sel_hi:[1,0]
    v_pk_add_f32 v[60:61], v[60:61], 1.0 op_sel_hi:[1,0]
    v_pk_add_f32 v[62:63], v[62:63], 1.0 op_sel_hi:[1,0]
    v_rcp_f32 v48, v48
    v_mfma_f32_32x32x16_bf16 v[16:31], v[84:87], v[104:107], v[16:31]
    v_rcp_f32 v49, v49
    v_rcp_f32 v50, v50
    v_rcp_f32 v51, v51
    v_mfma_f32_32x32x16_bf16 v[16:31], v[88:91], v[108:111], v[16:31]
    v_rcp_f32 v52, v52
    v_rcp_f32 v53, v53
    v_rcp_f32 v54, v54
    v_mfma_f32_32x32x16_bf16 v[16:31], v[92:95], v[112:115], v[16:31]
    v_rcp_f32 v55, v55
    v_rcp_f32 v56, v56
    v_rcp_f32 v57, v57
    v_mfma_f32_32x32x16_bf16 v[16:31], v[96:99], v[140:143], v[16:31]
    v_rcp_f32 v58, v58
    v_rcp_f32 v59, v59
    v_rcp_f32 v60, v60
    v_rcp_f32 v61, v61
    v_rcp_f32 v62, v62
    v_rcp_f32 v63, v63
    v_pk_mul_f32 v[48:49], v[48:49], v[32:33]
    v_pk_mul_f32 v[50:51], v[50:51], v[34:35]
    v_pk_mul_f32 v[52:53], v[52:53], v[36:37]
    v_pk_mul_f32 v[54:55], v[54:55], v[38:39]
    v_pk_mul_f32 v[56:57], v[56:57], v[40:41]
    v_pk_mul_f32 v[58:59], v[58:59], v[42:43]
    v_pk_mul_f32 v[60:61], v[60:61], v[44:45]
    v_pk_mul_f32 v[62:63], v[62:63], v[46:47]
    v_cvt_pk_bf16_f32 v64, v48, v49
    v_cvt_pk_bf16_f32 v65, v50, v51
    v_cvt_pk_bf16_f32 v66, v52, v53
    v_cvt_pk_bf16_f32 v67, v54, v55
    v_cvt_pk_bf16_f32 v68, v56, v57
    v_cvt_pk_bf16_f32 v69, v58, v59
    v_cvt_pk_bf16_f32 v70, v60, v61
    v_cvt_pk_bf16_f32 v71, v62, v63
K_XT1:
    v_exp_f32 v48, v16
    v_mfma_f32_32x32x16_bf16 v[164:179], v[72:75], v[64:67], v[164:179]
    v_and_b32 v247, 0x38, v228
    v_lshl_add_u32 v248, v247, 1, s75
    ds_read_b96 v[240:242], v248 offset:128
    v_bfe_u32 v253, v229, 7, 15
    v_exp_f32 v49, v17
    v_exp_f32 v50, v18
    v_exp_f32 v51, v19
    v_mfma_f32_32x32x16_bf16 v[164:179], v[76:79], v[68:71], v[164:179]
    v_exp_f32 v52, v20
    ds_read_b64_tr_b16 v[72:73], v220 offset:0
    ds_read_b64_tr_b16 v[74:75], v220 offset:512
    v_exp_f32 v53, v21
    ds_read_b64_tr_b16 v[76:77], v220 offset:1024
    ds_read_b64_tr_b16 v[78:79], v220 offset:1536
    v_exp_f32 v54, v22
    v_exp_f32 v55, v23
    v_exp_f32 v56, v24
    v_exp_f32 v57, v25
    v_exp_f32 v58, v26
    v_exp_f32 v59, v27
    v_exp_f32 v60, v28
    v_exp_f32 v61, v29
    v_exp_f32 v62, v30
    v_exp_f32 v63, v31
    v_pk_add_f32 v[48:49], v[48:49], 1.0 op_sel_hi:[1,0]
    v_pk_add_f32 v[50:51], v[50:51], 1.0 op_sel_hi:[1,0]
    v_pk_add_f32 v[52:53], v[52:53], 1.0 op_sel_hi:[1,0]
    v_pk_add_f32 v[54:55], v[54:55], 1.0 op_sel_hi:[1,0]
    v_pk_add_f32 v[56:57], v[56:57], 1.0 op_sel_hi:[1,0]
    v_pk_add_f32 v[58:59], v[58:59], 1.0 op_sel_hi:[1,0]
    v_pk_add_f32 v[60:61], v[60:61], 1.0 op_sel_hi:[1,0]
    v_pk_add_f32 v[62:63], v[62:63], 1.0 op_sel_hi:[1,0]
    v_rcp_f32 v48, v48
    v_mfma_f32_32x32x16_bf16 v[32:47], v[96:99], v[144:147], 0
    v_rcp_f32 v49, v49
    s_waitcnt vmcnt(4) lgkmcnt(4)
    s_mov_b64 exec, s[70:71]
    ds_read_b128 v[96:99], v248
    s_mov_b64 exec, s[72:73]
    v_sub_f32 v240, v240, v232
    v_sub_f32 v241, v241, v233
    v_sub_f32 v242, v242, v234
    v_cvt_pk_bf16_f32 v244, 1.0, v240
    v_cvt_pk_bf16_f32 v245, v241, v242
    v_dot2_f32_bf16 v252, v244, v244, -1.0
    v_dot2_f32_bf16 v252, v245, v245, v252
    ds_read2st64_b32 v[96:97], v230 offset0:74 offset1:148
    ds_write_b64 v246, v[250:251]
    v_add_u32 v246, v247, v221
    ds_write_b64 v246, v[244:245]
    buffer_load_dwordx3 v[232:234], v253, s[12:15], 0 idxen sc1
    v_cvt_pk_bf16_f32 v98, v252, v252
    s_mov_b64 exec, -1
    v_rcp_f32 v50, v50
    v_add_u32 v249, s78, v222
    v_add_u32 v230, s78, v223
    ds_read_b128 v[224:227], v249
    ds_read_b32 v228, v230
    s_add_u32 s78, s78, 128
    s_cmp_eq_u32 s78, s79
    s_cselect_b32 s78, s80, s78
    s_cselect_b32 s79, s81, s79
    v_rcp_f32 v51, v51
    v_mfma_f32_32x32x16_bf16 v[32:47], v[80:83], v[116:119], v[32:47]
    v_rcp_f32 v52, v52
    v_rcp_f32 v53, v53
    v_rcp_f32 v54, v54
    v_mfma_f32_32x32x16_bf16 v[32:47], v[84:87], v[120:123], v[32:47]
    v_rcp_f32 v55, v55
    v_rcp_f32 v56, v56
    v_rcp_f32 v57, v57
    v_mfma_f32_32x32x16_bf16 v[32:47], v[88:91], v[124:127], v[32:47]
    v_rcp_f32 v58, v58
    v_rcp_f32 v59, v59
    v_rcp_f32 v60, v60
    v_mfma_f32_32x32x16_bf16 v[32:47], v[92:95], v[128:131], v[32:47]
    v_rcp_f32 v61, v61
    ds_read_b128 v[80:83], v216 offset:0
    ds_read_b128 v[84:87], v217 offset:0
    ds_read_b128 v[88:91], v218 offset:0
    ds_read_b128 v[92:95], v219 offset:0
    v_rcp_f32 v62, v62
    v_rcp_f32 v63, v63
    v_pk_mul_f32 v[48:49], v[48:49], v[16:17]
    v_pk_mul_f32 v[50:51], v[50:51], v[18:19]
    v_pk_mul_f32 v[52:53], v[52:53], v[20:21]
    v_pk_mul_f32 v[54:55], v[54:55], v[22:23]
    v_pk_mul_f32 v[56:57], v[56:57], v[24:25]
    v_pk_mul_f32 v[58:59], v[58:59], v[26:27]
    v_pk_mul_f32 v[60:61], v[60:61], v[28:29]
    v_pk_mul_f32 v[62:63], v[62:63], v[30:31]
    v_cvt_pk_bf16_f32 v64, v48, v49
    v_cvt_pk_bf16_f32 v65, v50, v51
    v_cvt_pk_bf16_f32 v66, v52, v53
    v_cvt_pk_bf16_f32 v67, v54, v55
    v_cvt_pk_bf16_f32 v68, v56, v57
    v_cvt_pk_bf16_f32 v69, v58, v59
    v_cvt_pk_bf16_f32 v70, v60, v61
    v_cvt_pk_bf16_f32 v71, v62, v63
    s_branch K_YB1
K_YT1:
    s_waitcnt lgkmcnt(10)
    v_exp_f32 v48, v32
    v_mfma_f32_32x32x16_bf16 v[148:163], v[72:75], v[64:67], v[148:163]
    s_add_u32 m0, s86, 0
    v_exp_f32 v49, v33
    s_waitcnt lgkmcnt(5)
    v_and_or_b32 v224, v224, s74, v212
    v_and_or_b32 v225, v225, s74, v213
    v_and_or_b32 v226, v226, s74, v214
    v_and_or_b32 v227, v227, s74, v215
    v_exp_f32 v50, v34
    v_exp_f32 v51, v35
    v_mfma_f32_32x32x16_bf16 v[148:163], v[76:79], v[68:71], v[148:163]
    v_exp_f32 v52, v36
    v_exp_f32 v53, v37
    v_exp_f32 v54, v38
    s_waitcnt lgkmcnt(0)
    v_mfma_f32_32x32x16_bf16 v[16:31], v[80:83], v[100:103], 0
    v_exp_f32 v55, v39
    buffer_load_dwordx4 v224, s[32:35], 0 offen offset:0  lds
    v_exp_f32 v56, v40
    buffer_load_dwordx4 v225, s[36:39], 0 offen offset:1024  lds
    v_exp_f32 v57, v41
    v_exp_f32 v58, v42
    buffer_load_dwordx4 v226, s[40:43], 0 offen offset:2048  lds
    v_exp_f32 v59, v43
    buffer_load_dwordx4 v227, s[44:47], 0 offen offset:3072  lds
    v_exp_f32 v60, v44
    v_exp_f32 v61, v45
    v_exp_f32 v62, v46
    v_exp_f32 v63, v47
    v_pk_add_f32 v[48:49], v[48:49], 1.0 op_sel_hi:[1,0]
    v_pk_add_f32 v[50:51], v[50:51], 1.0 op_sel_hi:[1,0]
    v_pk_add_f32 v[52:53], v[52:53], 1.0 op_sel_hi:[1,0]
    v_pk_add_f32 v[54:55], v[54:55], 1.0 op_sel_hi:[1,0]
    v_pk_add_f32 v[56:57], v[56:57], 1.0 op_sel_hi:[1,0]
    v_pk_add_f32 v[58:59], v[58:59], 1.0 op_sel_hi:[1,0]
    v_pk_add_f32 v[60:61], v[60:61], 1.0 op_sel_hi:[1,0]
    v_pk_add_f32 v[62:63], v[62:63], 1.0 op_sel_hi:[1,0]
    v_rcp_f32 v48, v48
    v_mfma_f32_32x32x16_bf16 v[16:31], v[84:87], v[104:107], v[16:31]
    v_rcp_f32 v49, v49
    v_rcp_f32 v50, v50
    v_rcp_f32 v51, v51
    v_mfma_f32_32x32x16_bf16 v[16:31], v[88:91], v[108:111], v[16:31]
    v_rcp_f32 v52, v52
    v_rcp_f32 v53, v53
    v_rcp_f32 v54, v54
    v_mfma_f32_32x32x16_bf16 v[16:31], v[92:95], v[112:115], v[16:31]
    v_rcp_f32 v55, v55
    v_rcp_f32 v56, v56
    v_rcp_f32 v57, v57
    v_mfma_f32_32x32x16_bf16 v[16:31], v[96:99], v[140:143], v[16:31]
    v_rcp_f32 v58, v58
    v_rcp_f32 v59, v59
    v_rcp_f32 v60, v60
    v_rcp_f32 v61, v61
    v_rcp_f32 v62, v62
    v_rcp_f32 v63, v63
    v_pk_mul_f32 v[48:49], v[48:49], v[32:33]
    v_pk_mul_f32 v[50:51], v[50:51], v[34:35]
    v_pk_mul_f32 v[52:53], v[52:53], v[36:37]
    v_pk_mul_f32 v[54:55], v[54:55], v[38:39]
    v_pk_mul_f32 v[56:57], v[56:57], v[40:41]
    v_pk_mul_f32 v[58:59], v[58:59], v[42:43]
    v_pk_mul_f32 v[60:61], v[60:61], v[44:45]
    v_pk_mul_f32 v[62:63], v[62:63], v[46:47]
    v_cvt_pk_bf16_f32 v64, v48, v49
    v_cvt_pk_bf16_f32 v65, v50, v51
    v_cvt_pk_bf16_f32 v66, v52, v53
    v_cvt_pk_bf16_f32 v67, v54, v55
    v_cvt_pk_bf16_f32 v68, v56, v57
    v_cvt_pk_bf16_f32 v69, v58, v59
    v_cvt_pk_bf16_f32 v70, v60, v61
    v_cvt_pk_bf16_f32 v71, v62, v63
K_XT0:
    v_exp_f32 v48, v16
    v_mfma_f32_32x32x16_bf16 v[164:179], v[72:75], v[64:67], v[164:179]
    v_and_b32 v247, 0x38, v229
    v_lshl_add_u32 v248, v247, 1, s75
    ds_read_b96 v[240:242], v248 offset:128
    v_bfe_u32 v253, v228, 7, 15
    v_exp_f32 v49, v17
    v_exp_f32 v50, v18
    v_exp_f32 v51, v19
    v_mfma_f32_32x32x16_bf16 v[164:179], v[76:79], v[68:71], v[164:179]
    v_exp_f32 v52, v20
    ds_read_b64_tr_b16 v[72:73], v220 offset:0
    ds_read_b64_tr_b16 v[74:75], v220 offset:512
    v_exp_f32 v53, v21
    ds_read_b64_tr_b16 v[76:77], v220 offset:1024
    ds_read_b64_tr_b16 v[78:79], v220 offset:1536
    v_exp_f32 v54, v22
    v_exp_f32 v55, v23
    v_exp_f32 v56, v24
    v_exp_f32 v57, v25
    v_exp_f32 v58, v26
    v_exp_f32 v59, v27
    v_exp_f32 v60, v28
    v_exp_f32 v61, v29
    v_exp_f32 v62, v30
    v_exp_f32 v63, v31
    v_pk_add_f32 v[48:49], v[48:49], 1.0 op_sel_hi:[1,0]
    v_pk_add_f32 v[50:51], v[50:51], 1.0 op_sel_hi:[1,0]
    v_pk_add_f32 v[52:53], v[52:53], 1.0 op_sel_hi:[1,0]
    v_pk_add_f32 v[54:55], v[54:55], 1.0 op_sel_hi:[1,0]
    v_pk_add_f32 v[56:57], v[56:57], 1.0 op_sel_hi:[1,0]
    v_pk_add_f32 v[58:59], v[58:59], 1.0 op_sel_hi:[1,0]
    v_pk_add_f32 v[60:61], v[60:61], 1.0 op_sel_hi:[1,0]
    v_pk_add_f32 v[62:63], v[62:63], 1.0 op_sel_hi:[1,0]
    v_rcp_f32 v48, v48
    v_mfma_f32_32x32x16_bf16 v[32:47], v[96:99], v[144:147], 0
    v_rcp_f32 v49, v49
    s_waitcnt vmcnt(4) lgkmcnt(4)
    s_mov_b64 exec, s[70:71]
    ds_read_b128 v[96:99], v248
    s_mov_b64 exec, s[72:73]
    v_sub_f32 v240, v240, v232
    v_sub_f32 v241, v241, v233
    v_sub_f32 v242, v242, v234
    v_cvt_pk_bf16_f32 v244, 1.0, v240
    v_cvt_pk_bf16_f32 v245, v241, v242
    v_dot2_f32_bf16 v252, v244, v244, -1.0
    v_dot2_f32_bf16 v252, v245, v245, v252
    ds_read2st64_b32 v[96:97], v231 offset0:74 offset1:148
    ds_write_b64 v246, v[250:251]
    v_add_u32 v246, v247, v221
    ds_write_b64 v246, v[244:245]
    buffer_load_dwordx3 v[232:234], v253, s[12:15], 0 idxen sc1
    v_cvt_pk_bf16_f32 v98, v252, v252
    s_mov_b64 exec, -1
    v_rcp_f32 v50, v50
    v_add_u32 v249, s78, v222
    v_add_u32 v231, s78, v223
    ds_read_b128 v[224:227], v249
    ds_read_b32 v229, v231
    s_add_u32 s78, s78, 128
    s_cmp_eq_u32 s78, s79
    s_cselect_b32 s78, s80, s78
    s_cselect_b32 s79, s81, s79
    v_rcp_f32 v51, v51
    v_mfma_f32_32x32x16_bf16 v[32:47], v[80:83], v[116:119], v[32:47]
    v_rcp_f32 v52, v52
    v_rcp_f32 v53, v53
    v_rcp_f32 v54, v54
    v_mfma_f32_32x32x16_bf16 v[32:47], v[84:87], v[120:123], v[32:47]
    v_rcp_f32 v55, v55
    v_rcp_f32 v56, v56
    v_rcp_f32 v57, v57
    v_mfma_f32_32x32x16_bf16 v[32:47], v[88:91], v[124:127], v[32:47]
    v_rcp_f32 v58, v58
    v_rcp_f32 v59, v59
    v_rcp_f32 v60, v60
    v_mfma_f32_32x32x16_bf16 v[32:47], v[92:95], v[128:131], v[32:47]
    v_rcp_f32 v61, v61
    ds_read_b128 v[80:83], v216 offset:4096
    ds_read_b128 v[84:87], v217 offset:4096
    ds_read_b128 v[88:91], v218 offset:4096
    ds_read_b128 v[92:95], v219 offset:4096
    v_rcp_f32 v62, v62
    v_rcp_f32 v63, v63
    v_pk_mul_f32 v[48:49], v[48:49], v[16:17]
    v_pk_mul_f32 v[50:51], v[50:51], v[18:19]
    v_pk_mul_f32 v[52:53], v[52:53], v[20:21]
    v_pk_mul_f32 v[54:55], v[54:55], v[22:23]
    v_pk_mul_f32 v[56:57], v[56:57], v[24:25]
    v_pk_mul_f32 v[58:59], v[58:59], v[26:27]
    v_pk_mul_f32 v[60:61], v[60:61], v[28:29]
    v_pk_mul_f32 v[62:63], v[62:63], v[30:31]
    v_cvt_pk_bf16_f32 v64, v48, v49
    v_cvt_pk_bf16_f32 v65, v50, v51
    v_cvt_pk_bf16_f32 v66, v52, v53
    v_cvt_pk_bf16_f32 v67, v54, v55
    v_cvt_pk_bf16_f32 v68, v56, v57
    v_cvt_pk_bf16_f32 v69, v58, v59
    v_cvt_pk_bf16_f32 v70, v60, v61
    v_cvt_pk_bf16_f32 v71, v62, v63
K_YB0:
    s_waitcnt lgkmcnt(10)
    v_exp_f32 v48, v32
    v_mfma_f32_32x32x16_bf16 v[180:195], v[72:75], v[64:67], v[180:195]
    s_add_u32 m0, s86, 4096
    v_exp_f32 v49, v33
    s_waitcnt lgkmcnt(5)
    v_and_or_b32 v224, v224, s74, v212
    v_and_or_b32 v225, v225, s74, v213
    v_and_or_b32 v226, v226, s74, v214
    v_and_or_b32 v227, v227, s74, v215
    v_exp_f32 v50, v34
    v_exp_f32 v51, v35
    v_mfma_f32_32x32x16_bf16 v[180:195], v[76:79], v[68:71], v[180:195]
    v_exp_f32 v52, v36
    v_exp_f32 v53, v37
    v_exp_f32 v54, v38
    s_waitcnt lgkmcnt(0)
    v_mfma_f32_32x32x16_bf16 v[16:31], v[80:83], v[100:103], 0
    v_exp_f32 v55, v39
    buffer_load_dwordx4 v224, s[32:35], 0 offen offset:0  lds
    v_exp_f32 v56, v40
    buffer_load_dwordx4 v225, s[36:39], 0 offen offset:1024  lds
    v_exp_f32 v57, v41
    v_exp_f32 v58, v42
    buffer_load_dwordx4 v226, s[40:43], 0 offen offset:2048  lds
    v_exp_f32 v59, v43
    buffer_load_dwordx4 v227, s[44:47], 0 offen offset:3072  lds
    v_exp_f32 v60, v44
    v_exp_f32 v61, v45
    v_exp_f32 v62, v46
    v_exp_f32 v63, v47
    v_pk_add_f32 v[48:49], v[48:49], 1.0 op_sel_hi:[1,0]
    v_pk_add_f32 v[50:51], v[50:51], 1.0 op_sel_hi:[1,0]
    v_pk_add_f32 v[52:53], v[52:53], 1.0 op_sel_hi:[1,0]
    v_pk_add_f32 v[54:55], v[54:55], 1.0 op_sel_hi:[1,0]
    v_pk_add_f32 v[56:57], v[56:57], 1.0 op_sel_hi:[1,0]
    v_pk_add_f32 v[58:59], v[58:59], 1.0 op_sel_hi:[1,0]
    v_pk_add_f32 v[60:61], v[60:61], 1.0 op_sel_hi:[1,0]
    v_pk_add_f32 v[62:63], v[62:63], 1.0 op_sel_hi:[1,0]
    v_rcp_f32 v48, v48
    v_mfma_f32_32x32x16_bf16 v[16:31], v[84:87], v[104:107], v[16:31]
    v_rcp_f32 v49, v49
    v_rcp_f32 v50, v50
    v_rcp_f32 v51, v51
    v_mfma_f32_32x32x16_bf16 v[16:31], v[88:91], v[108:111], v[16:31]
    v_rcp_f32 v52, v52
    v_rcp_f32 v53, v53
    v_rcp_f32 v54, v54
    v_mfma_f32_32x32x16_bf16 v[16:31], v[92:95], v[112:115], v[16:31]
    v_rcp_f32 v55, v55
    v_rcp_f32 v56, v56
    v_rcp_f32 v57, v57
    v_mfma_f32_32x32x16_bf16 v[16:31], v[96:99], v[140:143], v[16:31]
    v_rcp_f32 v58, v58
    v_rcp_f32 v59, v59
    v_rcp_f32 v60, v60
    v_rcp_f32 v61, v61
    v_rcp_f32 v62, v62
    v_rcp_f32 v63, v63
    v_pk_mul_f32 v[48:49], v[48:49], v[32:33]
    v_pk_mul_f32 v[50:51], v[50:51], v[34:35]
    v_pk_mul_f32 v[52:53], v[52:53], v[36:37]
    v_pk_mul_f32 v[54:55], v[54:55], v[38:39]
    v_pk_mul_f32 v[56:57], v[56:57], v[40:41]
    v_pk_mul_f32 v[58:59], v[58:59], v[42:43]
    v_pk_mul_f32 v[60:61], v[60:61], v[44:45]
    v_pk_mul_f32 v[62:63], v[62:63], v[46:47]
    v_cvt_pk_bf16_f32 v64, v48, v49
    v_cvt_pk_bf16_f32 v65, v50, v51
    v_cvt_pk_bf16_f32 v66, v52, v53
    v_cvt_pk_bf16_f32 v67, v54, v55
    v_cvt_pk_bf16_f32 v68, v56, v57
    v_cvt_pk_bf16_f32 v69, v58, v59
    v_cvt_pk_bf16_f32 v70, v60, v61
    v_cvt_pk_bf16_f32 v71, v62, v63
    s_sub_u32 s85, s85, 1
    s_cmp_le_u32 s85, 1
    s_cbranch_scc1 K_TAIL
    v_exp_f32 v48, v16
    v_mfma_f32_32x32x16_bf16 v[196:211], v[72:75], v[64:67], v[196:211]
    v_and_b32 v247, 0x38, v228
    v_lshl_add_u32 v248, v247, 1, s75
    ds_read_b96 v[240:242], v248 offset:128
    v_bfe_u32 v253, v229, 7, 15
    v_exp_f32 v49, v17
    v_exp_f32 v50, v18
    v_exp_f32 v51, v19
    v_mfma_f32_32x32x16_bf16 v[196:211], v[76:79], v[68:71], v[196:211]
    v_exp_f32 v52, v20
    ds_read_b64_tr_b16 v[72:73], v220 offset:0
    ds_read_b64_tr_b16 v[74:75], v220 offset:512
    v_exp_f32 v53, v21
    ds_read_b64_tr_b16 v[76:77], v220 offset:1024
    ds_read_b64_tr_b16 v[78:79], v220 offset:1536
    v_exp_f32 v54, v22
    v_exp_f32 v55, v23
    v_exp_f32 v56, v24
    v_exp_f32 v57, v25
    v_exp_f32 v58, v26
    v_exp_f32 v59, v27
    v_exp_f32 v60, v28
    v_exp_f32 v61, v29
    v_exp_f32 v62, v30
    v_exp_f32 v63, v31
    v_pk_add_f32 v[48:49], v[48:49], 1.0 op_sel_hi:[1,0]
    v_pk_add_f32 v[50:51], v[50:51], 1.0 op_sel_hi:[1,0]
    v_pk_add_f32 v[52:53], v[52:53], 1.0 op_sel_hi:[1,0]
    v_pk_add_f32 v[54:55], v[54:55], 1.0 op_sel_hi:[1,0]
    v_pk_add_f32 v[56:57], v[56:57], 1.0 op_sel_hi:[1,0]
    v_pk_add_f32 v[58:59], v[58:59], 1.0 op_sel_hi:[1,0]
    v_pk_add_f32 v[60:61], v[60:61], 1.0 op_sel_hi:[1,0]
    v_pk_add_f32 v[62:63], v[62:63], 1.0 op_sel_hi:[1,0]
    v_rcp_f32 v48, v48
    v_mfma_f32_32x32x16_bf16 v[32:47], v[96:99], v[144:147], 0
    v_rcp_f32 v49, v49
    s_waitcnt vmcnt(4) lgkmcnt(4)
    s_mov_b64 exec, s[70:71]
    ds_read_b128 v[96:99], v248
    s_mov_b64 exec, s[72:73]
    v_sub_f32 v240, v240, v232
    v_sub_f32 v241, v241, v233
    v_sub_f32 v242, v242, v234
    v_cvt_pk_bf16_f32 v244, 1.0, v240
    v_cvt_pk_bf16_f32 v245, v241, v242
    v_dot2_f32_bf16 v252, v244, v244, -1.0
    v_dot2_f32_bf16 v252, v245, v245, v252
    ds_read2st64_b32 v[96:97], v230 offset0:74 offset1:148
    ds_write_b64 v246, v[250:251]
    v_add_u32 v246, v247, v221
    ds_write_b64 v246, v[244:245]
    buffer_load_dwordx3 v[232:234], v253, s[12:15], 0 idxen sc1
    v_cvt_pk_bf16_f32 v98, v252, v252
    s_mov_b64 exec, -1
    v_rcp_f32 v50, v50
    v_add_u32 v249, s78, v222
    v_add_u32 v230, s78, v223
    ds_read_b128 v[224:227], v249
    ds_read_b32 v228, v230
    s_add_u32 s78, s78, 128
    s_cmp_eq_u32 s78, s79
    s_cselect_b32 s78, s80, s78
    s_cselect_b32 s79, s81, s79
    v_rcp_f32 v51, v51
    v_mfma_f32_32x32x16_bf16 v[32:47], v[80:83], v[116:119], v[32:47]
    v_rcp_f32 v52, v52
    v_rcp_f32 v53, v53
    v_rcp_f32 v54, v54
    v_mfma_f32_32x32x16_bf16 v[32:47], v[84:87], v[120:123], v[32:47]
    v_rcp_f32 v55, v55
    v_rcp_f32 v56, v56
    v_rcp_f32 v57, v57
    v_mfma_f32_32x32x16_bf16 v[32:47], v[88:91], v[124:127], v[32:47]
    v_rcp_f32 v58, v58
    v_rcp_f32 v59, v59
    v_rcp_f32 v60, v60
    v_mfma_f32_32x32x16_bf16 v[32:47], v[92:95], v[128:131], v[32:47]
    v_rcp_f32 v61, v61
    ds_read_b128 v[80:83], v216 offset:0
    ds_read_b128 v[84:87], v217 offset:0
    ds_read_b128 v[88:91], v218 offset:0
    ds_read_b128 v[92:95], v219 offset:0
    v_rcp_f32 v62, v62
    v_rcp_f32 v63, v63
    v_pk_mul_f32 v[48:49], v[48:49], v[16:17]
    v_pk_mul_f32 v[50:51], v[50:51], v[18:19]
    v_pk_mul_f32 v[52:53], v[52:53], v[20:21]
    v_pk_mul_f32 v[54:55], v[54:55], v[22:23]
    v_pk_mul_f32 v[56:57], v[56:57], v[24:25]
    v_pk_mul_f32 v[58:59], v[58:59], v[26:27]
    v_pk_mul_f32 v[60:61], v[60:61], v[28:29]
    v_pk_mul_f32 v[62:63], v[62:63], v[30:31]
    v_cvt_pk_bf16_f32 v64, v48, v49
    v_cvt_pk_bf16_f32 v65, v50, v51
    v_cvt_pk_bf16_f32 v66, v52, v53
    v_cvt_pk_bf16_f32 v67, v54, v55
    v_cvt_pk_bf16_f32 v68, v56, v57
    v_cvt_pk_bf16_f32 v69, v58, v59
    v_cvt_pk_bf16_f32 v70, v60, v61
    v_cvt_pk_bf16_f32 v71, v62, v63
K_YB1:
    s_waitcnt lgkmcnt(10)
    v_exp_f32 v48, v32
    v_mfma_f32_32x32x16_bf16 v[180:195], v[72:75], v[64:67], v[180:195]
    s_add_u32 m0, s86, 0
    v_exp_f32 v49, v33
    s_waitcnt lgkmcnt(5)
    v_and_or_b32 v224, v224, s74, v212
    v_and_or_b32 v225, v225, s74, v213
    v_and_or_b32 v226, v226, s74, v214
    v_and_or_b32 v227, v227, s74, v215
    v_exp_f32 v50, v34
    v_exp_f32 v51, v35
    v_mfma_f32_32x32x16_bf16 v[180:195], v[76:79], v[68:71], v[180:195]
    v_exp_f32 v52, v36
    v_exp_f32 v53, v37
    v_exp_f32 v54, v38
    s_waitcnt lgkmcnt(0)
    v_mfma_f32_32x32x16_bf16 v[16:31], v[80:83], v[100:103], 0
    v_exp_f32 v55, v39
    buffer_load_dwordx4 v224, s[32:35], 0 offen offset:0  lds
    v_exp_f32 v56, v40
    buffer_load_dwordx4 v225, s[36:39], 0 offen offset:1024  lds
    v_exp_f32 v57, v41
    v_exp_f32 v58, v42
    buffer_load_dwordx4 v226, s[40:43], 0 offen offset:2048  lds
    v_exp_f32 v59, v43
    buffer_load_dwordx4 v227, s[44:47], 0 offen offset:3072  lds
    v_exp_f32 v60, v44
    v_exp_f32 v61, v45
    v_exp_f32 v62, v46
    v_exp_f32 v63, v47
    v_pk_add_f32 v[48:49], v[48:49], 1.0 op_sel_hi:[1,0]
    v_pk_add_f32 v[50:51], v[50:51], 1.0 op_sel_hi:[1,0]
    v_pk_add_f32 v[52:53], v[52:53], 1.0 op_sel_hi:[1,0]
    v_pk_add_f32 v[54:55], v[54:55], 1.0 op_sel_hi:[1,0]
    v_pk_add_f32 v[56:57], v[56:57], 1.0 op_sel_hi:[1,0]
    v_pk_add_f32 v[58:59], v[58:59], 1.0 op_sel_hi:[1,0]
    v_pk_add_f32 v[60:61], v[60:61], 1.0 op_sel_hi:[1,0]
    v_pk_add_f32 v[62:63], v[62:63], 1.0 op_sel_hi:[1,0]
    v_rcp_f32 v48, v48
    v_mfma_f32_32x32x16_bf16 v[16:31], v[84:87], v[104:107], v[16:31]
    v_rcp_f32 v49, v49
    v_rcp_f32 v50, v50
    v_rcp_f32 v51, v51
    v_mfma_f32_32x32x16_bf16 v[16:31], v[88:91], v[108:111], v[16:31]
    v_rcp_f32 v52, v52
    v_rcp_f32 v53, v53
    v_rcp_f32 v54, v54
    v_mfma_f32_32x32x16_bf16 v[16:31], v[92:95], v[112:115], v[16:31]
    v_rcp_f32 v55, v55
    v_rcp_f32 v56, v56
    v_rcp_f32 v57, v57
    v_mfma_f32_32x32x16_bf16 v[16:31], v[96:99], v[140:143], v[16:31]
    v_rcp_f32 v58, v58
    v_rcp_f32 v59, v59
    v_rcp_f32 v60, v60
    v_rcp_f32 v61, v61
    v_rcp_f32 v62, v62
    v_rcp_f32 v63, v63
    v_pk_mul_f32 v[48:49], v[48:49], v[32:33]
    v_pk_mul_f32 v[50:51], v[50:51], v[34:35]
    v_pk_mul_f32 v[52:53], v[52:53], v[36:37]
    v_pk_mul_f32 v[54:55], v[54:55], v[38:39]
    v_pk_mul_f32 v[56:57], v[56:57], v[40:41]
    v_pk_mul_f32 v[58:59], v[58:59], v[42:43]
    v_pk_mul_f32 v[60:61], v[60:61], v[44:45]
    v_pk_mul_f32 v[62:63], v[62:63], v[46:47]
    v_cvt_pk_bf16_f32 v64, v48, v49
    v_cvt_pk_bf16_f32 v65, v50, v51
    v_cvt_pk_bf16_f32 v66, v52, v53
    v_cvt_pk_bf16_f32 v67, v54, v55
    v_cvt_pk_bf16_f32 v68, v56, v57
    v_cvt_pk_bf16_f32 v69, v58, v59
    v_cvt_pk_bf16_f32 v70, v60, v61
    v_cvt_pk_bf16_f32 v71, v62, v63
    s_sub_u32 s85, s85, 1
    s_cmp_le_u32 s85, 1
    s_cbranch_scc1 K_TAIL
    v_exp_f32 v48, v16
    v_mfma_f32_32x32x16_bf16 v[196:211], v[72:75], v[64:67], v[196:211]
    v_and_b32 v247, 0x38, v229
    v_lshl_add_u32 v248, v247, 1, s75
    ds_read_b96 v[240:242], v248 offset:128
    v_bfe_u32 v253, v228, 7, 15
    v_exp_f32 v49, v17
    v_exp_f32 v50, v18
    v_exp_f32 v51, v19
    v_mfma_f32_32x32x16_bf16 v[196:211], v[76:79], v[68:71], v[196:211]
    v_exp_f32 v52, v20
    ds_read_b64_tr_b16 v[72:73], v220 offset:0
    ds_read_b64_tr_b16 v[74:75], v220 offset:512
    v_exp_f32 v53, v21
    ds_read_b64_tr_b16 v[76:77], v220 offset:1024
    ds_read_b64_tr_b16 v[78:79], v220 offset:1536
    v_exp_f32 v54, v22
    v_exp_f32 v55, v23
    v_exp_f32 v56, v24
    v_exp_f32 v57, v25
    v_exp_f32 v58, v26
    v_exp_f32 v59, v27
    v_exp_f32 v60, v28
    v_exp_f32 v61, v29
    v_exp_f32 v62, v30
    v_exp_f32 v63, v31
    v_pk_add_f32 v[48:49], v[48:49], 1.0 op_sel_hi:[1,0]
    v_pk_add_f32 v[50:51], v[50:51], 1.0 op_sel_hi:[1,0]
    v_pk_add_f32 v[52:53], v[52:53], 1.0 op_sel_hi:[1,0]
    v_pk_add_f32 v[54:55], v[54:55], 1.0 op_sel_hi:[1,0]
    v_pk_add_f32 v[56:57], v[56:57], 1.0 op_sel_hi:[1,0]
    v_pk_add_f32 v[58:59], v[58:59], 1.0 op_sel_hi:[1,0]
    v_pk_add_f32 v[60:61], v[60:61], 1.0 op_sel_hi:[1,0]
    v_pk_add_f32 v[62:63], v[62:63], 1.0 op_sel_hi:[1,0]
    v_rcp_f32 v48, v48
    v_mfma_f32_32x32x16_bf16 v[32:47], v[96:99], v[144:147], 0
    v_rcp_f32 v49, v49
    s_waitcnt vmcnt(4) lgkmcnt(4)
    s_mov_b64 exec, s[70:71]
    ds_read_b128 v[96:99], v248
    s_mov_b64 exec, s[72:73]
    v_sub_f32 v240, v240, v232
    v_sub_f32 v241, v241, v233
    v_sub_f32 v242, v242, v234
    v_cvt_pk_bf16_f32 v244, 1.0, v240
    v_cvt_pk_bf16_f32 v245, v241, v242
    v_dot2_f32_bf16 v252, v244, v244, -1.0
    v_dot2_f32_bf16 v252, v245, v245, v252
    ds_read2st64_b32 v[96:97], v231 offset0:74 offset1:148
    ds_write_b64 v246, v[250:251]
    v_add_u32 v246, v247, v221
    ds_write_b64 v246, v[244:245]
    buffer_load_dwordx3 v[232:234], v253, s[12:15], 0 idxen sc1
    v_cvt_pk_bf16_f32 v98, v252, v252
    s_mov_b64 exec, -1
    v_rcp_f32 v50, v50
    v_add_u32 v249, s78, v222
    v_add_u32 v231, s78, v223
    ds_read_b128 v[224:227], v249
    ds_read_b32 v229, v231
    s_add_u32 s78, s78, 128
    s_cmp_eq_u32 s78, s79
    s_cselect_b32 s78, s80, s78
    s_cselect_b32 s79, s81, s79
    v_rcp_f32 v51, v51
    v_mfma_f32_32x32x16_bf16 v[32:47], v[80:83], v[116:119], v[32:47]
    v_rcp_f32 v52, v52
    v_rcp_f32 v53, v53
    v_rcp_f32 v54, v54
    v_mfma_f32_32x32x16_bf16 v[32:47], v[84:87], v[120:123], v[32:47]
    v_rcp_f32 v55, v55
    v_rcp_f32 v56, v56
    v_rcp_f32 v57, v57
    v_mfma_f32_32x32x16_bf16 v[32:47], v[88:91], v[124:127], v[32:47]
    v_rcp_f32 v58, v58
    v_rcp_f32 v59, v59
    v_rcp_f32 v60, v60
    v_mfma_f32_32x32x16_bf16 v[32:47], v[92:95], v[128:131], v[32:47]
    v_rcp_f32 v61, v61
    ds_read_b128 v[80:83], v216 offset:4096
    ds_read_b128 v[84:87], v217 offset:4096
    ds_read_b128 v[88:91], v218 offset:4096
    ds_read_b128 v[92:95], v219 offset:4096
    v_rcp_f32 v62, v62
    v_rcp_f32 v63, v63
    v_pk_mul_f32 v[48:49], v[48:49], v[16:17]
    v_pk_mul_f32 v[50:51], v[50:51], v[18:19]
    v_pk_mul_f32 v[52:53], v[52:53], v[20:21]
    v_pk_mul_f32 v[54:55], v[54:55], v[22:23]
    v_pk_mul_f32 v[56:57], v[56:57], v[24:25]
    v_pk_mul_f32 v[58:59], v[58:59], v[26:27]
    v_pk_mul_f32 v[60:61], v[60:61], v[28:29]
    v_pk_mul_f32 v[62:63], v[62:63], v[30:31]
    v_cvt_pk_bf16_f32 v64, v48, v49
    v_cvt_pk_bf16_f32 v65, v50, v51
    v_cvt_pk_bf16_f32 v66, v52, v53
    v_cvt_pk_bf16_f32 v67, v54, v55
    v_cvt_pk_bf16_f32 v68, v56, v57
    v_cvt_pk_bf16_f32 v69, v58, v59
    v_cvt_pk_bf16_f32 v70, v60, v61
    v_cvt_pk_bf16_f32 v71, v62, v63
    s_branch K_YB0
K_TAIL:
    s_cmp_eq_u32 s85, 0
    s_cbranch_scc1 K_DRAIN
    s_cmp_eq_u32 s53, 12
    s_cbranch_scc1 K_TAIL12
    s_cmp_eq_u32 s53, 8
    s_cbranch_scc1 K_TAIL8
    s_cmp_eq_u32 s53, 4
    s_cbranch_scc1 K_TAIL4
K_TAIL16:
    v_exp_f32 v48, v16
    v_mfma_f32_32x32x16_bf16 v[196:211], v[72:75], v[64:67], v[196:211]
    v_exp_f32 v49, v17
    v_exp_f32 v50, v18
    v_exp_f32 v51, v19
    v_mfma_f32_32x32x16_bf16 v[196:211], v[76:79], v[68:71], v[196:211]
    v_exp_f32 v52, v20
    ds_read_b64_tr_b16 v[72:73], v220 offset:0
    ds_read_b64_tr_b16 v[74:75], v220 offset:512
    v_exp_f32 v53, v21
    ds_read_b64_tr_b16 v[76:77], v220 offset:1024
    ds_read_b64_tr_b16 v[78:79], v220 offset:1536
    v_exp_f32 v54, v22
    v_exp_f32 v55, v23
    v_exp_f32 v56, v24
    v_exp_f32 v57, v25
    v_exp_f32 v58, v26
    v_exp_f32 v59, v27
    v_exp_f32 v60, v28
    v_exp_f32 v61, v29
    v_exp_f32 v62, v30
    v_exp_f32 v63, v31
    v_pk_add_f32 v[48:49], v[48:49], 1.0 op_sel_hi:[1,0]
    v_pk_add_f32 v[50:51], v[50:51], 1.0 op_sel_hi:[1,0]
    v_pk_add_f32 v[52:53], v[52:53], 1.0 op_sel_hi:[1,0]
    v_pk_add_f32 v[54:55], v[54:55], 1.0 op_sel_hi:[1,0]
    v_pk_add_f32 v[56:57], v[56:57], 1.0 op_sel_hi:[1,0]
    v_pk_add_f32 v[58:59], v[58:59], 1.0 op_sel_hi:[1,0]
    v_pk_add_f32 v[60:61], v[60:61], 1.0 op_sel_hi:[1,0]
    v_pk_add_f32 v[62:63], v[62:63], 1.0 op_sel_hi:[1,0]
    v_rcp_f32 v48, v48
    v_mfma_f32_32x32x16_bf16 v[32:47], v[96:99], v[144:147], 0
    v_rcp_f32 v49, v49
    v_rcp_f32 v50, v50
    v_rcp_f32 v51, v51
    v_mfma_f32_32x32x16_bf16 v[32:47], v[80:83], v[116:119], v[32:47]
    v_rcp_f32 v52, v52
    v_rcp_f32 v53, v53
    v_rcp_f32 v54, v54
    v_mfma_f32_32x32x16_bf16 v[32:47], v[84:87], v[120:123], v[32:47]
    v_rcp_f32 v55, v55
    v_rcp_f32 v56, v56
    v_rcp_f32 v57, v57
    v_mfma_f32_32x32x16_bf16 v[32:47], v[88:91], v[124:127], v[32:47]
    v_rcp_f32 v58, v58
    v_rcp_f32 v59, v59
    v_rcp_f32 v60, v60
    v_mfma_f32_32x32x16_bf16 v[32:47], v[92:95], v[128:131], v[32:47]
    v_rcp_f32 v61, v61
    v_rcp_f32 v62, v62
    v_rcp_f32 v63, v63
    v_pk_mul_f32 v[48:49], v[48:49], v[16:17]
    v_pk_mul_f32 v[50:51], v[50:51], v[18:19]
    v_pk_mul_f32 v[52:53], v[52:53], v[20:21]
    v_pk_mul_f32 v[54:55], v[54:55], v[22:23]
    v_pk_mul_f32 v[56:57], v[56:57], v[24:25]
    v_pk_mul_f32 v[58:59], v[58:59], v[26:27]
    v_pk_mul_f32 v[60:61], v[60:61], v[28:29]
    v_pk_mul_f32 v[62:63], v[62:63], v[30:31]
    v_cvt_pk_bf16_f32 v64, v48, v49
    v_cvt_pk_bf16_f32 v65, v50, v51
    v_cvt_pk_bf16_f32 v66, v52, v53
    v_cvt_pk_bf16_f32 v67, v54, v55
    v_cvt_pk_bf16_f32 v68, v56, v57
    v_cvt_pk_bf16_f32 v69, v58, v59
    v_cvt_pk_bf16_f32 v70, v60, v61
    v_cvt_pk_bf16_f32 v71, v62, v63
    s_waitcnt lgkmcnt(0)
    v_exp_f32 v48, v32
    v_mfma_f32_32x32x16_bf16 v[180:195], v[72:75], v[64:67], v[180:195]
    v_exp_f32 v49, v33
    v_exp_f32 v50, v34
    v_exp_f32 v51, v35
    v_mfma_f32_32x32x16_bf16 v[180:195], v[76:79], v[68:71], v[180:195]
    v_exp_f32 v52, v36
    v_exp_f32 v53, v37
    v_exp_f32 v54, v38
    v_exp_f32 v55, v39
    v_exp_f32 v56, v40
    v_exp_f32 v57, v41
    v_exp_f32 v58, v42
    v_exp_f32 v59, v43
    v_exp_f32 v60, v44
    v_exp_f32 v61, v45
    v_exp_f32 v62, v46
    v_exp_f32 v63, v47
    v_pk_add_f32 v[48:49], v[48:49], 1.0 op_sel_hi:[1,0]
    v_pk_add_f32 v[50:51], v[50:51], 1.0 op_sel_hi:[1,0]
    v_pk_add_f32 v[52:53], v[52:53], 1.0 op_sel_hi:[1,0]
    v_pk_add_f32 v[54:55], v[54:55], 1.0 op_sel_hi:[1,0]
    v_pk_add_f32 v[56:57], v[56:57], 1.0 op_sel_hi:[1,0]
    v_pk_add_f32 v[58:59], v[58:59], 1.0 op_sel_hi:[1,0]
    v_pk_add_f32 v[60:61], v[60:61], 1.0 op_sel_hi:[1,0]
    v_pk_add_f32 v[62:63], v[62:63], 1.0 op_sel_hi:[1,0]
    v_rcp_f32 v48, v48
    v_rcp_f32 v49, v49
    v_rcp_f32 v50, v50
    v_rcp_f32 v51, v51
    v_rcp_f32 v52, v52
    v_rcp_f32 v53, v53
    v_rcp_f32 v54, v54
    v_rcp_f32 v55, v55
    v_rcp_f32 v56, v56
    v_rcp_f32 v57, v57
    v_rcp_f32 v58, v58
    v_rcp_f32 v59, v59
    v_rcp_f32 v60, v60
    v_rcp_f32 v61, v61
    v_rcp_f32 v62, v62
    v_rcp_f32 v63, v63
    v_pk_mul_f32 v[48:49], v[48:49], v[32:33]
    v_pk_mul_f32 v[50:51], v[50:51], v[34:35]
    v_pk_mul_f32 v[52:53], v[52:53], v[36:37]
    v_pk_mul_f32 v[54:55], v[54:55], v[38:39]
    v_pk_mul_f32 v[56:57], v[56:57], v[40:41]
    v_pk_mul_f32 v[58:59], v[58:59], v[42:43]
    v_pk_mul_f32 v[60:61], v[60:61], v[44:45]
    v_pk_mul_f32 v[62:63], v[62:63], v[46:47]
    v_cvt_pk_bf16_f32 v64, v48, v49
    v_cvt_pk_bf16_f32 v65, v50, v51
    v_cvt_pk_bf16_f32 v66, v52, v53
    v_cvt_pk_bf16_f32 v67, v54, v55
    v_cvt_pk_bf16_f32 v68, v56, v57
    v_cvt_pk_bf16_f32 v69, v58, v59
    v_cvt_pk_bf16_f32 v70, v60, v61
    v_cvt_pk_bf16_f32 v71, v62, v63
    s_nop 0
    s_branch K_DRAIN
K_TAIL12:
    v_exp_f32 v48, v16
    v_mfma_f32_32x32x16_bf16 v[196:211], v[72:75], v[64:67], v[196:211]
    v_exp_f32 v49, v17
    v_exp_f32 v50, v18
    v_exp_f32 v51, v19
    v_mfma_f32_32x32x16_bf16 v[196:211], v[76:79], v[68:71], v[196:211]
    v_exp_f32 v52, v20
    ds_read_b64_tr_b16 v[72:73], v220 offset:0
    ds_read_b64_tr_b16 v[74:75], v220 offset:512
    v_exp_f32 v53, v21
    ds_read_b64_tr_b16 v[76:77], v220 offset:1024
    ds_read_b64_tr_b16 v[78:79], v220 offset:1536
    v_exp_f32 v54, v22
    v_mfma_f32_32x32x16_bf16 v[32:47], v[96:99], v[144:147], 0
    v_exp_f32 v55, v23
    v_exp_f32 v56, v24
    v_exp_f32 v57, v25
    v_exp_f32 v58, v26
    v_exp_f32 v59, v27
    v_pk_add_f32 v[48:49], v[48:49], 1.0 op_sel_hi:[1,0]
    v_pk_add_f32 v[50:51], v[50:51], 1.0 op_sel_hi:[1,0]
    v_pk_add_f32 v[52:53], v[52:53], 1.0 op_sel_hi:[1,0]
    v_pk_add_f32 v[54:55], v[54:55], 1.0 op_sel_hi:[1,0]
    v_pk_add_f32 v[56:57], v[56:57], 1.0 op_sel_hi:[1,0]
    v_pk_add_f32 v[58:59], v[58:59], 1.0 op_sel_hi:[1,0]
    v_rcp_f32 v48, v48
    v_mfma_f32_32x32x16_bf16 v[32:47], v[80:83], v[116:119], v[32:47]
    v_rcp_f32 v49, v49
    v_rcp_f32 v50, v50
    v_rcp_f32 v51, v51
    v_mfma_f32_32x32x16_bf16 v[32:47], v[84:87], v[120:123], v[32:47]
    v_rcp_f32 v52, v52
    v_rcp_f32 v53, v53
    v_rcp_f32 v54, v54
    v_mfma_f32_32x32x16_bf16 v[32:47], v[88:91], v[124:127], v[32:47]
    v_rcp_f32 v55, v55
    v_rcp_f32 v56, v56
    v_rcp_f32 v57, v57
    v_rcp_f32 v58, v58
    v_rcp_f32 v59, v59
    v_pk_mul_f32 v[48:49], v[48:49], v[16:17]
    v_pk_mul_f32 v[50:51], v[50:51], v[18:19]
    v_pk_mul_f32 v[52:53], v[52:53], v[20:21]
    v_pk_mul_f32 v[54:55], v[54:55], v[22:23]
    v_pk_mul_f32 v[56:57], v[56:57], v[24:25]
    v_pk_mul_f32 v[58:59], v[58:59], v[26:27]
    v_cvt_pk_bf16_f32 v64, v48, v49
    v_mfma_f32_32x32x16_bf16 v[32:47], v[92:95], v[128:131], v[32:47]
    v_cvt_pk_bf16_f32 v65, v50, v51
    v_cvt_pk_bf16_f32 v66, v52, v53
    v_cvt_pk_bf16_f32 v67, v54, v55
    v_cvt_pk_bf16_f32 v68, v56, v57
    v_cvt_pk_bf16_f32 v69, v58, v59
    s_waitcnt lgkmcnt(0)
    s_nop 5
    v_exp_f32 v48, v32
    v_mfma_f32_32x32x16_bf16 v[180:195], v[72:75], v[64:67], v[180:195]
    v_exp_f32 v49, v33
    v_exp_f32 v50, v34
    v_exp_f32 v51, v35
    v_mfma_f32_32x32x16_bf16 v[180:195], v[76:79], v[68:71], v[180:195]
    v_exp_f32 v52, v36
    v_exp_f32 v53, v37
    v_exp_f32 v54, v38
    v_exp_f32 v55, v39
    v_exp_f32 v56, v40
    v_exp_f32 v57, v41
    v_exp_f32 v58, v42
    v_exp_f32 v59, v43
    v_pk_add_f32 v[48:49], v[48:49], 1.0 op_sel_hi:[1,0]
    v_pk_add_f32 v[50:51], v[50:51], 1.0 op_sel_hi:[1,0]
    v_pk_add_f32 v[52:53], v[52:53], 1.0 op_sel_hi:[1,0]
    v_pk_add_f32 v[54:55], v[54:55], 1.0 op_sel_hi:[1,0]
    v_pk_add_f32 v[56:57], v[56:57], 1.0 op_sel_hi:[1,0]
    v_pk_add_f32 v[58:59], v[58:59], 1.0 op_sel_hi:[1,0]
    v_rcp_f32 v48, v48
    v_rcp_f32 v49, v49
    v_rcp_f32 v50, v50
    v_rcp_f32 v51, v51
    v_rcp_f32 v52, v52
    v_rcp_f32 v53, v53
    v_rcp_f32 v54, v54
    v_rcp_f32 v55, v55
    v_rcp_f32 v56, v56
    v_rcp_f32 v57, v57
    v_rcp_f32 v58, v58
    v_rcp_f32 v59, v59
    v_pk_mul_f32 v[48:49], v[48:49], v[32:33]
    v_pk_mul_f32 v[50:51], v[50:51], v[34:35]
    v_pk_mul_f32 v[52:53], v[52:53], v[36:37]
    v_pk_mul_f32 v[54:55], v[54:55], v[38:39]
    v_pk_mul_f32 v[56:57], v[56:57], v[40:41]
    v_pk_mul_f32 v[58:59], v[58:59], v[42:43]
    v_cvt_pk_bf16_f32 v64, v48, v49
    v_cvt_pk_bf16_f32 v65, v50, v51
    v_cvt_pk_bf16_f32 v66, v52, v53
    v_cvt_pk_bf16_f32 v67, v54, v55
    v_cvt_pk_bf16_f32 v68, v56, v57
    v_cvt_pk_bf16_f32 v69, v58, v59
    s_nop 0
    s_branch K_DRAIN
K_TAIL8:
    v_exp_f32 v48, v16
    v_mfma_f32_32x32x16_bf16 v[196:211], v[72:75], v[64:67], v[196:211]
    v_exp_f32 v49, v17
    v_exp_f32 v50, v18
    v_exp_f32 v51, v19
    v_mfma_f32_32x32x16_bf16 v[196:211], v[76:79], v[68:71], v[196:211]
    v_exp_f32 v52, v20
    ds_read_b64_tr_b16 v[72:73], v220 offset:0
    ds_read_b64_tr_b16 v[74:75], v220 offset:512
    v_exp_f32 v53, v21
    ds_read_b64_tr_b16 v[76:77], v220 offset:1024
    ds_read_b64_tr_b16 v[78:79], v220 offset:1536
    v_exp_f32 v54, v22
    v_exp_f32 v55, v23
    v_pk_add_f32 v[48:49], v[48:49], 1.0 op_sel_hi:[1,0]
    v_pk_add_f32 v[50:51], v[50:51], 1.0 op_sel_hi:[1,0]
    v_pk_add_f32 v[52:53], v[52:53], 1.0 op_sel_hi:[1,0]
    v_pk_add_f32 v[54:55], v[54:55], 1.0 op_sel_hi:[1,0]
    v_rcp_f32 v48, v48
    v_mfma_f32_32x32x16_bf16 v[32:47], v[96:99], v[144:147], 0
    v_rcp_f32 v49, v49
    v_rcp_f32 v50, v50
    v_rcp_f32 v51, v51
    v_mfma_f32_32x32x16_bf16 v[32:47], v[80:83], v[116:119], v[32:47]
    v_rcp_f32 v52, v52
    v_rcp_f32 v53, v53
    v_rcp_f32 v54, v54
    v_mfma_f32_32x32x16_bf16 v[32:47], v[84:87], v[120:123], v[32:47]
    v_rcp_f32 v55, v55
    v_pk_mul_f32 v[48:49], v[48:49], v[16:17]
    v_pk_mul_f32 v[50:51], v[50:51], v[18:19]
    v_pk_mul_f32 v[52:53], v[52:53], v[20:21]
    v_pk_mul_f32 v[54:55], v[54:55], v[22:23]
    v_cvt_pk_bf16_f32 v64, v48, v49
    v_mfma_f32_32x32x16_bf16 v[32:47], v[88:91], v[124:127], v[32:47]
    v_cvt_pk_bf16_f32 v65, v50, v51
    v_cvt_pk_bf16_f32 v66, v52, v53
    v_mfma_f32_32x32x16_bf16 v[32:47], v[92:95], v[128:131], v[32:47]
    v_cvt_pk_bf16_f32 v67, v54, v55
    s_waitcnt lgkmcnt(0)
    s_nop 9
    v_exp_f32 v48, v32
    v_mfma_f32_32x32x16_bf16 v[180:195], v[72:75], v[64:67], v[180:195]
    v_exp_f32 v49, v33
    v_exp_f32 v50, v34
    v_exp_f32 v51, v35
    v_exp_f32 v52, v36
    v_exp_f32 v53, v37
    v_exp_f32 v54, v38
    v_exp_f32 v55, v39
    v_pk_add_f32 v[48:49], v[48:49], 1.0 op_sel_hi:[1,0]
    v_pk_add_f32 v[50:51], v[50:51], 1.0 op_sel_hi:[1,0]
    v_pk_add_f32 v[52:53], v[52:53], 1.0 op_sel_hi:[1,0]
    v_pk_add_f32 v[54:55], v[54:55], 1.0 op_sel_hi:[1,0]
    v_rcp_f32 v48, v48
    v_rcp_f32 v49, v49
    v_rcp_f32 v50, v50
    v_rcp_f32 v51, v51
    v_rcp_f32 v52, v52
    v_rcp_f32 v53, v53
    v_rcp_f32 v54, v54
    v_rcp_f32 v55, v55
    v_pk_mul_f32 v[48:49], v[48:49], v[32:33]
    v_pk_mul_f32 v[50:51], v[50:51], v[34:35]
    v_pk_mul_f32 v[52:53], v[52:53], v[36:37]
    v_pk_mul_f32 v[54:55], v[54:55], v[38:39]
    v_cvt_pk_bf16_f32 v64, v48, v49
    v_cvt_pk_bf16_f32 v65, v50, v51
    v_cvt_pk_bf16_f32 v66, v52, v53
    v_cvt_pk_bf16_f32 v67, v54, v55
    s_nop 0
    s_branch K_DRAIN
K_TAIL4:
    v_exp_f32 v48, v16
    v_mfma_f32_32x32x16_bf16 v[196:211], v[72:75], v[64:67], v[196:211]
    v_exp_f32 v49, v17
    v_exp_f32 v50, v18
    v_exp_f32 v51, v19
    v_mfma_f32_32x32x16_bf16 v[196:211], v[76:79], v[68:71], v[196:211]
    v_pk_add_f32 v[48:49], v[48:49], 1.0 op_sel_hi:[1,0]
    ds_read_b64_tr_b16 v[72:73], v220 offset:0
    ds_read_b64_tr_b16 v[74:75], v220 offset:512
    v_pk_add_f32 v[50:51], v[50:51], 1.0 op_sel_hi:[1,0]
    ds_read_b64_tr_b16 v[76:77], v220 offset:1024
    ds_read_b64_tr_b16 v[78:79], v220 offset:1536
    v_rcp_f32 v48, v48
    v_mfma_f32_32x32x16_bf16 v[32:47], v[96:99], v[144:147], 0
    v_rcp_f32 v49, v49
    v_rcp_f32 v50, v50
    v_rcp_f32 v51, v51
    v_mfma_f32_32x32x16_bf16 v[32:47], v[80:83], v[116:119], v[32:47]
    v_pk_mul_f32 v[48:49], v[48:49], v[16:17]
    v_pk_mul_f32 v[50:51], v[50:51], v[18:19]
    v_cvt_pk_bf16_f32 v64, v48, v49
    v_mfma_f32_32x32x16_bf16 v[32:47], v[84:87], v[120:123], v[32:47]
    v_cvt_pk_bf16_f32 v65, v50, v51
    v_mfma_f32_32x32x16_bf16 v[32:47], v[88:91], v[124:127], v[32:47]
    v_mfma_f32_32x32x16_bf16 v[32:47], v[92:95], v[128:131], v[32:47]
    s_waitcnt lgkmcnt(0)
    s_nop 10
    v_exp_f32 v48, v32
    v_mfma_f32_32x32x16_bf16 v[180:195], v[72:75], v[64:67], v[180:195]
    v_exp_f32 v49, v33
    v_exp_f32 v50, v34
    v_exp_f32 v51, v35
    v_pk_add_f32 v[48:49], v[48:49], 1.0 op_sel_hi:[1,0]
    v_pk_add_f32 v[50:51], v[50:51], 1.0 op_sel_hi:[1,0]
    v_rcp_f32 v48, v48
    v_rcp_f32 v49, v49
    v_rcp_f32 v50, v50
    v_rcp_f32 v51, v51
    v_pk_mul_f32 v[48:49], v[48:49], v[32:33]
    v_pk_mul_f32 v[50:51], v[50:51], v[34:35]
    v_cvt_pk_bf16_f32 v64, v48, v49
    v_cvt_pk_bf16_f32 v65, v50, v51
K_DRAIN:
    s_nop 1
    v_mfma_f32_32x32x16_bf16 v[196:211], v[72:75], v[64:67], v[196:211]
    v_mfma_f32_32x32x16_bf16 v[196:211], v[76:79], v[68:71], v[196:211]
    s_cmp_eq_u32 s89, 0
    s_cbranch_scc1 K_EPI
    s_setprio 0
    s_mov_b64 exec, s[72:73]
    ds_write_b64 v246, v[250:251]
    s_mov_b64 exec, -1
    v_lshlrev_b32 v16, 4, v1
    s_mov_b32 s3, s94
    s_nop 7
    buffer_store_dwordx4 v[148:151], v16, s[28:31], s3 offen offset:0 sc0 sc1
    buffer_store_dwordx4 v[152:155], v16, s[28:31], s3 offen offset:1024 sc0 sc1
    buffer_store_dwordx4 v[156:159], v16, s[28:31], s3 offen offset:2048 sc0 sc1
    buffer_store_dwordx4 v[160:163], v16, s[28:31], s3 offen offset:3072 sc0 sc1
    s_add_u32 s3, s3, 4096
    buffer_store_dwordx4 v[164:167], v16, s[28:31], s3 offen offset:0 sc0 sc1
    buffer_store_dwordx4 v[168:171], v16, s[28:31], s3 offen offset:1024 sc0 sc1
    buffer_store_dwordx4 v[172:175], v16, s[28:31], s3 offen offset:2048 sc0 sc1
    buffer_store_dwordx4 v[176:179], v16, s[28:31], s3 offen offset:3072 sc0 sc1
    s_add_u32 s3, s3, 4096
    buffer_store_dwordx4 v[180:183], v16, s[28:31], s3 offen offset:0 sc0 sc1
    buffer_store_dwordx4 v[184:187], v16, s[28:31], s3 offen offset:1024 sc0 sc1
    buffer_store_dwordx4 v[188:191], v16, s[28:31], s3 offen offset:2048 sc0 sc1
    buffer_store_dwordx4 v[192:195], v16, s[28:31], s3 offen offset:3072 sc0 sc1
    s_add_u32 s3, s3, 4096
    buffer_store_dwordx4 v[196:199], v16, s[28:31], s3 offen offset:0 sc0 sc1
    buffer_store_dwordx4 v[200:203], v16, s[28:31], s3 offen offset:1024 sc0 sc1
    buffer_store_dwordx4 v[204:207], v16, s[28:31], s3 offen offset:2048 sc0 sc1
    buffer_store_dwordx4 v[208:211], v16, s[28:31], s3 offen offset:3072 sc0 sc1
    s_add_u32 s3, s3, 4096
    s_mov_b32 s88, 2
    s_waitcnt vmcnt(0) lgkmcnt(0)
    s_barrier
    s_branch K_RESET
K_EPI:
    v_lshrrev_b32 v100, 4, v1
    v_lshlrev_b32 v100, 4, v100
    v_bfe_u32 v101, v1, 2, 2
    v_add_u32 v100, v100, v101
    v_lshlrev_b32 v100, 7, v100
    v_and_b32 v101, 3, v1
    v_lshl_add_u32 v100, v101, 5, v100
    v_add_u32 v100, 86272, v100
    s_mov_b32 s4, 0xbf317218
    v_lshrrev_b32 v102, 5, v1
    v_lshlrev_b32 v102, 7, v102
    v_lshrrev_b32 v103, 1, v223
    s_lshl_b32 s5, s64, 11
    s_add_u32 s5, s5, 4352
    v_add3_u32 v102, v102, v103, s5
    v_and_b32 v103, 15, v1
    v_lshlrev_b32 v103, 7, v103
    v_lshrrev_b32 v104, 4, v1
    v_lshl_add_u32 v103, v104, 5, v103
    v_add_u32 v103, s5, v103
    ds_read_b64_tr_b16 v[16:17], v100 offset:0
    ds_read_b64_tr_b16 v[18:19], v100 offset:512
    ds_read_b64_tr_b16 v[32:33], v100 offset:8
    ds_read_b64_tr_b16 v[34:35], v100 offset:520
    ds_read_b64_tr_b16 v[48:49], v100 offset:16
    ds_read_b64_tr_b16 v[50:51], v100 offset:528
    ds_read_b64_tr_b16 v[80:81], v100 offset:24
    ds_read_b64_tr_b16 v[82:83], v100 offset:536
    v_mul_f32 v148, s4, v148
    v_mul_f32 v164, s4, v164
    v_cvt_pk_bf16_f32 v148, v148, v164
    ds_write_b16 v102, v148 offset:0
    ds_write_b16_d16_hi v102, v148 offset:64
    v_mul_f32 v152, s4, v152
    v_mul_f32 v168, s4, v168
    v_cvt_pk_bf16_f32 v152, v152, v168
    ds_write_b16 v102, v152 offset:256
    ds_write_b16_d16_hi v102, v152 offset:320
    ds_read_b64_tr_b16 v[20:21], v100 offset:1024
    ds_read_b64_tr_b16 v[22:23], v100 offset:1536
    ds_read_b64_tr_b16 v[36:37], v100 offset:1032
    ds_read_b64_tr_b16 v[38:39], v100 offset:1544
    ds_read_b64_tr_b16 v[52:53], v100 offset:1040
    ds_read_b64_tr_b16 v[54:55], v100 offset:1552
    ds_read_b64_tr_b16 v[84:85], v100 offset:1048
    ds_read_b64_tr_b16 v[86:87], v100 offset:1560
    v_mul_f32 v156, s4, v156
    v_mul_f32 v172, s4, v172
    v_cvt_pk_bf16_f32 v156, v156, v172
    ds_write_b16 v102, v156 offset:512
    ds_write_b16_d16_hi v102, v156 offset:576
    v_mul_f32 v160, s4, v160
    v_mul_f32 v176, s4, v176
    v_cvt_pk_bf16_f32 v160, v160, v176
    ds_write_b16 v102, v160 offset:768
    ds_write_b16_d16_hi v102, v160 offset:832
    ds_read_b64_tr_b16 v[24:25], v100 offset:8192
    ds_read_b64_tr_b16 v[26:27], v100 offset:8704
    ds_read_b64_tr_b16 v[40:41], v100 offset:8200
    ds_read_b64_tr_b16 v[42:43], v100 offset:8712
    ds_read_b64_tr_b16 v[56:57], v100 offset:8208
    ds_read_b64_tr_b16 v[58:59], v100 offset:8720
    ds_read_b64_tr_b16 v[88:89], v100 offset:8216
    ds_read_b64_tr_b16 v[90:91], v100 offset:8728
    v_mul_f32 v180, s4, v180
    v_mul_f32 v196, s4, v196
    v_cvt_pk_bf16_f32 v180, v180, v196
    ds_write_b16 v102, v180 offset:1024
    ds_write_b16_d16_hi v102, v180 offset:1088
    v_mul_f32 v184, s4, v184
    v_mul_f32 v200, s4, v200
    v_cvt_pk_bf16_f32 v184, v184, v200
    ds_write_b16 v102, v184 offset:1280
    ds_write_b16_d16_hi v102, v184 offset:1344
    ds_read_b64_tr_b16 v[28:29], v100 offset:9216
    ds_read_b64_tr_b16 v[30:31], v100 offset:9728
    ds_read_b64_tr_b16 v[44:45], v100 offset:9224
    ds_read_b64_tr_b16 v[46:47], v100 offset:9736
    ds_read_b64_tr_b16 v[60:61], v100 offset:9232
    ds_read_b64_tr_b16 v[62:63], v100 offset:9744
    ds_read_b64_tr_b16 v[92:93], v100 offset:9240
    ds_read_b64_tr_b16 v[94:95], v100 offset:9752
    v_mul_f32 v188, s4, v188
    v_mul_f32 v204, s4, v204
    v_cvt_pk_bf16_f32 v188, v188, v204
    ds_write_b16 v102, v188 offset:1536
    ds_write_b16_d16_hi v102, v188 offset:1600
    v_mul_f32 v192, s4, v192
    v_mul_f32 v208, s4, v208
    v_cvt_pk_bf16_f32 v192, v192, v208
    ds_write_b16 v102, v192 offset:1792
    ds_write_b16_d16_hi v102, v192 offset:1856
    ds_read_b128 v[108:111], v103
    ds_read_b128 v[112:115], v103 offset:16
    v_lshlrev_b32 v243, 16, v243
    v_mul_f32 v243, s4, v243
    v_lshlrev_b32 v254, 16, v254
    v_mul_f32 v254, s4, v254
    v_mul_f32 v149, v243, v149
    v_fmac_f32 v149, v254, v165
    v_mul_f32 v150, v243, v150
    v_fmac_f32 v150, v254, v166
    v_mul_f32 v151, v243, v151
    v_fmac_f32 v151, v254, v167
    v_mul_f32 v153, v243, v153
    v_fmac_f32 v153, v254, v169
    v_mul_f32 v154, v243, v154
    v_fmac_f32 v154, v254, v170
    v_mul_f32 v155, v243, v155
    v_fmac_f32 v155, v254, v171
    v_mul_f32 v157, v243, v157
    v_fmac_f32 v157, v254, v173
    v_mul_f32 v158, v243, v158
    v_fmac_f32 v158, v254, v174
    v_mul_f32 v159, v243, v159
    v_fmac_f32 v159, v254, v175
    v_mul_f32 v161, v243, v161
    v_fmac_f32 v161, v254, v177
    v_mul_f32 v162, v243, v162
    v_fmac_f32 v162, v254, v178
    v_mul_f32 v163, v243, v163
    v_fmac_f32 v163, v254, v179
    v_mul_f32 v181, v243, v181
    v_fmac_f32 v181, v254, v197
    v_mul_f32 v182, v243, v182
    v_fmac_f32 v182, v254, v198
    v_mul_f32 v183, v243, v183
    v_fmac_f32 v183, v254, v199
    v_mul_f32 v185, v243, v185
    v_fmac_f32 v185, v254, v201
    v_mul_f32 v186, v243, v186
    v_fmac_f32 v186, v254, v202
    v_mul_f32 v187, v243, v187
    v_fmac_f32 v187, v254, v203
    v_mul_f32 v189, v243, v189
    v_fmac_f32 v189, v254, v205
    v_mul_f32 v190, v243, v190
    v_fmac_f32 v190, v254, v206
    v_mul_f32 v191, v243, v191
    v_fmac_f32 v191, v254, v207
    v_mul_f32 v193, v243, v193
    v_fmac_f32 v193, v254, v209
    v_mul_f32 v194, v243, v194
    v_fmac_f32 v194, v254, v210
    v_mul_f32 v195, v243, v195
    v_fmac_f32 v195, v254, v211
    s_waitcnt lgkmcnt(0)
    v_mfma_f32_16x16x32_bf16 v[116:119], v[16:19], v[8:11], 0
    v_permlane16_swap_b32 v149, v181
    v_permlane16_swap_b32 v150, v182
    v_mfma_f32_16x16x32_bf16 v[120:123], v[32:35], v[8:11], 0
    v_permlane16_swap_b32 v151, v183
    v_permlane16_swap_b32 v153, v185
    v_mfma_f32_16x16x32_bf16 v[124:127], v[48:51], v[8:11], 0
    v_permlane16_swap_b32 v154, v186
    v_permlane16_swap_b32 v155, v187
    v_mfma_f32_16x16x32_bf16 v[128:131], v[80:83], v[8:11], 0
    v_permlane16_swap_b32 v157, v189
    v_permlane16_swap_b32 v158, v190
    v_mfma_f32_16x16x32_bf16 v[116:119], v[20:23], v[12:15], v[116:119]
    v_permlane16_swap_b32 v159, v191
    v_permlane16_swap_b32 v161, v193
    v_mfma_f32_16x16x32_bf16 v[120:123], v[36:39], v[12:15], v[120:123]
    v_permlane16_swap_b32 v162, v194
    v_permlane16_swap_b32 v163, v195
    v_mfma_f32_16x16x32_bf16 v[124:127], v[52:55], v[12:15], v[124:127]
    v_add_f32 v149, v149, v181
    v_add_f32 v150, v150, v182
    v_mfma_f32_16x16x32_bf16 v[128:131], v[84:87], v[12:15], v[128:131]
    v_add_f32 v151, v151, v183
    v_add_f32 v153, v153, v185
    v_mfma_f32_16x16x32_bf16 v[116:119], v[24:27], v[108:111], v[116:119]
    v_add_f32 v154, v154, v186
    v_add_f32 v155, v155, v187
    v_mfma_f32_16x16x32_bf16 v[120:123], v[40:43], v[108:111], v[120:123]
    v_add_f32 v157, v157, v189
    v_add_f32 v158, v158, v190
    v_mfma_f32_16x16x32_bf16 v[124:127], v[56:59], v[108:111], v[124:127]
    v_add_f32 v159, v159, v191
    v_add_f32 v161, v161, v193
    v_mfma_f32_16x16x32_bf16 v[128:131], v[88:91], v[108:111], v[128:131]
    v_add_f32 v162, v162, v194
    v_add_f32 v163, v163, v195
    v_mfma_f32_16x16x32_bf16 v[116:119], v[28:31], v[112:115], v[116:119]
    v_add_f32_dpp v165, v149, v149 row_ror:8 row_mask:0xf bank_mask:0x3
    v_add_f32_dpp v165, v157, v157 row_ror:8 row_mask:0xf bank_mask:0xc
    v_mfma_f32_16x16x32_bf16 v[120:123], v[44:47], v[112:115], v[120:123]
    v_add_f32_dpp v166, v150, v150 row_ror:8 row_mask:0xf bank_mask:0x3
    v_add_f32_dpp v166, v158, v158 row_ror:8 row_mask:0xf bank_mask:0xc
    v_mfma_f32_16x16x32_bf16 v[124:127], v[60:63], v[112:115], v[124:127]
    v_add_f32_dpp v167, v151, v151 row_ror:8 row_mask:0xf bank_mask:0x3
    v_add_f32_dpp v167, v159, v159 row_ror:8 row_mask:0xf bank_mask:0xc
    v_mfma_f32_16x16x32_bf16 v[128:131], v[92:95], v[112:115], v[128:131]
    v_add_f32_dpp v169, v153, v153 row_ror:8 row_mask:0xf bank_mask:0x3
    v_add_f32_dpp v169, v161, v161 row_ror:8 row_mask:0xf bank_mask:0xc
    v_add_f32_dpp v170, v154, v154 row_ror:8 row_mask:0xf bank_mask:0x3
    v_add_f32_dpp v170, v162, v162 row_ror:8 row_mask:0xf bank_mask:0xc
    v_add_f32_dpp v171, v155, v155 row_ror:8 row_mask:0xf bank_mask:0x3
    v_add_f32_dpp v171, v163, v163 row_ror:8 row_mask:0xf bank_mask:0xc
    v_add_f32_dpp v197, v165, v165 row_shl:4 row_mask:0xf bank_mask:0x5
    v_add_f32_dpp v197, v169, v169 row_shr:4 row_mask:0xf bank_mask:0xa
    v_add_f32_dpp v198, v166, v166 row_shl:4 row_mask:0xf bank_mask:0x5
    v_add_f32_dpp v198, v170, v170 row_shr:4 row_mask:0xf bank_mask:0xa
    v_add_f32_dpp v199, v167, v167 row_shl:4 row_mask:0xf bank_mask:0x5
    v_add_f32_dpp v199, v171, v171 row_shr:4 row_mask:0xf bank_mask:0xa
    v_add_f32_dpp v197, v197, v197 quad_perm:[1,0,3,2] row_mask:0xf bank_mask:0xf
    v_add_f32_dpp v198, v198, v198 quad_perm:[1,0,3,2] row_mask:0xf bank_mask:0xf
    v_add_f32_dpp v199, v199, v199 quad_perm:[1,0,3,2] row_mask:0xf bank_mask:0xf
    v_add_f32_dpp v197, v197, v197 quad_perm:[2,3,0,1] row_mask:0xf bank_mask:0xf
    v_add_f32_dpp v198, v198, v198 quad_perm:[2,3,0,1] row_mask:0xf bank_mask:0xf
    v_add_f32_dpp v199, v199, v199 quad_perm:[2,3,0,1] row_mask:0xf bank_mask:0xf
    v_cmp_eq_u32 vcc, 1, v101
    v_lshlrev_b32 v238, 16, v238
    s_mov_b32 s4, 0xbfb8aa3b
    v_cndmask_b32 v105, v197, v198, vcc
    v_cmp_eq_u32 vcc, 2, v101
    s_mov_b32 s5, s4
    s_mov_b32 s3, 3200000
    v_cndmask_b32 v105, v105, v199, vcc
    v_add_f32 v105, v105, v238
    v_cvt_pk_bf16_f32 v105, v105, v105
    buffer_store_short v105, v237, s[24:27], s3 offen nt
    v_pk_mul_f32 v[148:149], v[116:117], s[4:5]
    v_pk_mul_f32 v[150:151], v[118:119], s[4:5]
    v_pk_mul_f32 v[152:153], v[120:121], s[4:5]
    v_pk_mul_f32 v[154:155], v[122:123], s[4:5]
    v_pk_mul_f32 v[156:157], v[124:125], s[4:5]
    v_pk_mul_f32 v[158:159], v[126:127], s[4:5]
    v_pk_mul_f32 v[160:161], v[128:129], s[4:5]
    v_pk_mul_f32 v[162:163], v[130:131], s[4:5]
    v_exp_f32 v148, v148
    v_exp_f32 v149, v149
    v_exp_f32 v150, v150
    v_exp_f32 v151, v151
    v_exp_f32 v152, v152
    v_exp_f32 v153, v153
    v_exp_f32 v154, v154
    v_exp_f32 v155, v155
    v_exp_f32 v156, v156
    v_exp_f32 v157, v157
    v_exp_f32 v158, v158
    v_exp_f32 v159, v159
    v_exp_f32 v160, v160
    v_exp_f32 v161, v161
    v_exp_f32 v162, v162
    v_exp_f32 v163, v163
    v_pk_add_f32 v[148:149], v[148:149], 1.0 op_sel_hi:[1,0]
    v_pk_add_f32 v[150:151], v[150:151], 1.0 op_sel_hi:[1,0]
    v_pk_add_f32 v[152:153], v[152:153], 1.0 op_sel_hi:[1,0]
    v_pk_add_f32 v[154:155], v[154:155], 1.0 op_sel_hi:[1,0]
    v_pk_add_f32 v[156:157], v[156:157], 1.0 op_sel_hi:[1,0]
    v_pk_add_f32 v[158:159], v[158:159], 1.0 op_sel_hi:[1,0]
    v_pk_add_f32 v[160:161], v[160:161], 1.0 op_sel_hi:[1,0]
    v_pk_add_f32 v[162:163], v[162:163], 1.0 op_sel_hi:[1,0]
    v_rcp_f32 v148, v148
    v_rcp_f32 v149, v149
    v_rcp_f32 v150, v150
    v_rcp_f32 v151, v151
    v_rcp_f32 v152, v152
    v_rcp_f32 v153, v153
    v_rcp_f32 v154, v154
    v_rcp_f32 v155, v155
    v_rcp_f32 v156, v156
    v_rcp_f32 v157, v157
    v_rcp_f32 v158, v158
    v_rcp_f32 v159, v159
    v_rcp_f32 v160, v160
    v_rcp_f32 v161, v161
    v_rcp_f32 v162, v162
    v_rcp_f32 v163, v163
    v_lshlrev_b32 v164, 16, v8
    v_and_b32 v165, 0xffff0000, v8
    v_lshlrev_b32 v166, 16, v9
    v_and_b32 v167, 0xffff0000, v9
    v_lshlrev_b32 v168, 16, v10
    v_and_b32 v169, 0xffff0000, v10
    v_lshlrev_b32 v170, 16, v11
    v_and_b32 v171, 0xffff0000, v11
    v_lshlrev_b32 v172, 16, v12
    v_and_b32 v173, 0xffff0000, v12
    v_lshlrev_b32 v174, 16, v13
    v_and_b32 v175, 0xffff0000, v13
    v_lshlrev_b32 v176, 16, v14
    v_and_b32 v177, 0xffff0000, v14
    v_lshlrev_b32 v178, 16, v15
    v_and_b32 v179, 0xffff0000, v15
    v_pk_fma_f32 v[148:149], v[148:149], v[116:117], v[164:165]
    v_pk_fma_f32 v[150:151], v[150:151], v[118:119], v[166:167]
    v_pk_fma_f32 v[152:153], v[152:153], v[120:121], v[168:169]
    v_pk_fma_f32 v[154:155], v[154:155], v[122:123], v[170:171]
    v_pk_fma_f32 v[156:157], v[156:157], v[124:125], v[172:173]
    v_pk_fma_f32 v[158:159], v[158:159], v[126:127], v[174:175]
    v_pk_fma_f32 v[160:161], v[160:161], v[128:129], v[176:177]
    v_pk_fma_f32 v[162:163], v[162:163], v[130:131], v[178:179]
    v_cvt_pk_bf16_f32 v180, v148, v149
    v_cvt_pk_bf16_f32 v181, v150, v151
    v_cvt_pk_bf16_f32 v182, v152, v153
    v_cvt_pk_bf16_f32 v183, v154, v155
    v_cvt_pk_bf16_f32 v184, v156, v157
    v_cvt_pk_bf16_f32 v185, v158, v159
    v_cvt_pk_bf16_f32 v186, v160, v161
    v_cvt_pk_bf16_f32 v187, v162, v163
    buffer_store_dwordx4 v[180:183], v236, s[24:27], 0 offen nt
    buffer_store_dwordx4 v[184:187], v236, s[24:27], 0 offen offset:16 nt
K_END:
    s_endpgm
.section .rodata,"a"
.p2align 6
.amdhsa_kernel gather_scatter__cheap_equivariant_egnn__graph_kernel
  .amdhsa_next_free_vgpr 256
  .amdhsa_next_free_sgpr 102
  .amdhsa_accum_offset 256
  .amdhsa_group_segment_fixed_size 0
  .amdhsa_kernarg_size 88
  .amdhsa_user_sgpr_count 2
  .amdhsa_user_sgpr_kernarg_segment_ptr 1
  .amdhsa_system_sgpr_workgroup_id_x 1
  .amdhsa_float_denorm_mode_32 3
.end_amdhsa_kernel
```
